```python
import torch

def _softmax(x, axis=-1):
    return torch.softmax(x, dim=axis)
def _gelu(x):
    return torch.nn.functional.gelu(x, approximate="tanh")
def _silu(x):
    return torch.nn.functional.silu(x)
def _sigmoid(x):
    return torch.sigmoid(x)
def _layernorm(x, axis=-1, eps=1e-5):
    m = x.mean(dim=axis, keepdim=True)
    v = x.var(dim=axis, keepdim=True, unbiased=False)
    return (x - m) / torch.sqrt(v + eps)
def _scatter_add(tgt, idx, src, axis=0):
    return tgt.clone().index_add_(axis, idx, src)
def _segment_sum(src, seg, n):
    out = torch.zeros((n,) + src.shape[1:], dtype=src.dtype)
    return out.index_add_(0, seg, src)
def _pad(x, pw):
    flat = tuple(v for pair in reversed(pw) for v in pair)
    return torch.nn.functional.pad(x, flat)

kernel_name = 'standalone__gqa_block_cached__near_ridge'

def setup_inputs():

    _w = (lambda a: (lambda t: t.to(torch.bfloat16) if t.is_floating_point() else t)(torch.as_tensor(a)))
    B, Sq, D = 8, 64, 512
    Hq, Hkv, Sk, Dh = 32, 8, 512, 128
    assert Hq % Hkv == 0, (Hq, Hkv)
    return {
        "x": _w((lambda *s: torch.randn(*s, dtype=torch.bfloat16) * 0.8)(B, Sq, D)),
        "k_cache": _w((lambda *s: torch.randn(*s, dtype=torch.bfloat16) * 0.8)(B, Hkv, Sk, Dh)),
        "v_cache": _w((lambda *s: torch.randn(*s, dtype=torch.bfloat16) * 0.05)(B, Hkv, Sk, Dh)),
        "wq": _w((lambda *s: torch.randn(*s, dtype=torch.bfloat16) * 0.8)(D, Hq * Dh) * (D ** -0.5)),
        "wo": _w((lambda *s: torch.randn(*s, dtype=torch.bfloat16) * 0.05)(Hq * Dh, D) * ((Hq * Dh) ** -0.5)),
    }

def reference(x, k_cache, v_cache, wq, wo):
    B, Sq, D = x.shape
    Hq, Dh = 32, 128
    Hkv = k_cache.shape[1]
    rep = Hq // Hkv
    q = (lambda x, *d: x.permute(*d))((x @ wq).reshape(B, Sq, Hq, Dh), 0, 2, 1, 3)
    k = (lambda x, n, axis: torch.repeat_interleave(x, n, dim=axis))(k_cache, rep, axis=1)
    v = (lambda x, n, axis: torch.repeat_interleave(x, n, dim=axis))(v_cache, rep, axis=1)
    scores = torch.einsum("bhqd,bhkd->bhqk", q, k) * (Dh ** -0.5)
    p = _softmax(scores, axis=-1)
    o = torch.einsum("bhqk,bhkd->bhqd", p, v)
    return (lambda x, *d: x.permute(*d))(o, 0, 2, 1, 3).reshape(B, Sq, Hq * Dh) @ wo
```

```asm
; @launch kernel=gqa_attn_kernel grid=(256,1,1) block=(512,1,1) lds=163840
; @launch kernel=gqa_oproj_kernel grid=(256,1,1) block=(512,1,1) lds=33024
.amdgcn_target "amdgcn-amd-amdhsa--gfx950"
.text
.globl gqa_attn_kernel
.p2align 8
.type gqa_attn_kernel,@function
gqa_attn_kernel:
    s_cmp_ge_u32 s2, 256
    s_cbranch_scc1 K1_END
    s_load_dwordx8 s[4:11], s[0:1], 0
    s_load_dwordx2 s[12:13], s[0:1], 32
    s_load_dwordx2 s[14:15], s[0:1], 56
    v_and_b32 v1, 63, v0
    v_lshrrev_b32 v2, 6, v0
    s_nop 0
    v_readfirstlane_b32 s53, v2
    s_and_b32 s43, s2, 7
    s_lshr_b32 s56, s2, 3
    s_lshr_b32 s41, s56, 2
    s_and_b32 s71, s56, 3
    s_lshl_b32 s69, s71, 1
    s_add_u32 s69, s69, s41
    s_lshl_b32 s42, s43, 2
    s_add_u32 s42, s42, s71
    s_and_b32 s40, s53, 3
    s_mul_i32 s51, s40, 8704
    s_add_u32 s49, s51, 77184
    s_add_u32 s52, s51, 34816
    s_add_u32 s50, s51, 112000
    s_add_u32 s56, s51, 128384
    s_cmp_ge_u32 s40, 2
    s_cselect_b32 s50, s56, s50
    s_cmp_ge_u32 s53, 4
    s_cbranch_scc1 K1_LOADER
    v_lshrrev_b32 v23, 4, v1
    v_lshlrev_b32 v5, 4, v1
    v_and_b32 v25, 31, v1
    v_lshrrev_b32 v26, 5, v1
    v_lshlrev_b32 v20, 2, v25
    v_and_b32 v21, 7, v25
    v_mul_u32_u24 v21, 1040, v21
    v_lshrrev_b32 v22, 3, v25
    v_lshl_add_u32 v27, v22, 7, v21
    v_lshl_add_u32 v7, v26, 4, v27
    v_lshl_add_u32 v27, v22, 8, v21
    v_lshl_add_u32 v27, v26, 4, v27
    v_and_b32 v28, 1, v22
    v_lshlrev_b32 v28, 7, v28
    v_add_u32 v11, v27, v28
    v_sub_u32 v12, v27, v28
    v_and_b32 v27, 1, v23
    v_lshrrev_b32 v28, 2, v1
    v_and_b32 v28, 3, v28
    v_and_b32 v29, 3, v1
    v_lshlrev_b32 v21, 5, v27
    v_mul_u32_u24 v22, 1088, v28
    v_lshl_add_u32 v62, v26, 8, v22
    v_add_u32 v62, v62, v21
    v_lshl_add_u32 v15, v29, 3, v62
    s_mul_i32 s56, s40, 4352
    s_add_u32 s56, s56, 112000
    v_add_u32 v15, s56, v15
    v_lshl_add_u32 v63, v26, 9, v22
    v_add_u32 v63, v63, v21
    v_and_b32 v22, 1, v29
    v_lshlrev_b32 v22, 4, v22
    v_lshrrev_b32 v62, 1, v29
    v_lshl_add_u32 v22, v62, 3, v22
    v_add_u32 v8, v63, v22
    s_lshl_b32 s56, s40, 6
    v_add_u32 v8, s56, v8
    s_lshl_b32 s56, s40, 12
    s_add_u32 s56, s56, 34816
    v_add_u32 v16, s56, v5
    s_lshl_b32 s66, s40, 10
    s_add_u32 s66, s66, s2
    s_lshl_b32 s66, s66, 10
    s_add_u32 s66, s66, 4194304
    s_mov_b32 s68, 0x3e0293ee
    s_waitcnt lgkmcnt(0)
    s_mov_b32 s36, s14
    s_and_b32 s37, s15, 0xffff
    s_mov_b32 s38, 8388608
    s_mov_b32 s39, 0x00020000
    s_barrier
    v_add_u32 v9, 0, v7
    v_add_u32 v10, 8320, v8
    ds_read_b64_tr_b16 v[80:81], v10 offset:0
    ds_read_b64_tr_b16 v[82:83], v10 offset:256
    ds_read_b128 v[84:87], v9 offset:0
    ds_read_b128 v[88:91], v9 offset:512
    ds_read_b64_tr_b16 v[92:93], v10 offset:4352
    ds_read_b64_tr_b16 v[94:95], v10 offset:4608
    ds_read_b128 v[96:99], v9 offset:32
    ds_read_b128 v[100:103], v9 offset:544
    ds_read_b64_tr_b16 v[104:105], v10 offset:8704
    ds_read_b64_tr_b16 v[106:107], v10 offset:8960
    ds_read_b128 v[108:111], v9 offset:64
    ds_read_b128 v[112:115], v9 offset:576
    s_waitcnt lgkmcnt(8)
    v_mfma_f32_32x32x16_bf16 v[160:175], v[80:83], v[84:87], 0
    v_mfma_f32_32x32x16_bf16 v[176:191], v[80:83], v[88:91], 0
    ds_read_b64_tr_b16 v[80:81], v10 offset:13056
    ds_read_b64_tr_b16 v[82:83], v10 offset:13312
    ds_read_b128 v[84:87], v9 offset:96
    ds_read_b128 v[88:91], v9 offset:608
    s_waitcnt lgkmcnt(8)
    v_mfma_f32_32x32x16_bf16 v[160:175], v[92:95], v[96:99], v[160:175]
    v_mfma_f32_32x32x16_bf16 v[176:191], v[92:95], v[100:103], v[176:191]
    s_waitcnt lgkmcnt(0)
    s_barrier
    v_add_u32 v9, 25728, v7
    v_add_u32 v10, 34048, v8
    ds_read_b64_tr_b16 v[92:93], v10 offset:0
    ds_read_b64_tr_b16 v[94:95], v10 offset:256
    ds_read_b128 v[96:99], v9 offset:0
    ds_read_b128 v[100:103], v9 offset:512
    v_mfma_f32_32x32x16_bf16 v[160:175], v[104:107], v[108:111], v[160:175]
    v_mfma_f32_32x32x16_bf16 v[176:191], v[104:107], v[112:115], v[176:191]
    ds_read_b64_tr_b16 v[104:105], v10 offset:4352
    ds_read_b64_tr_b16 v[106:107], v10 offset:4608
    ds_read_b128 v[108:111], v9 offset:32
    ds_read_b128 v[112:115], v9 offset:544
    v_mfma_f32_32x32x16_bf16 v[160:175], v[80:83], v[84:87], v[160:175]
    v_mfma_f32_32x32x16_bf16 v[176:191], v[80:83], v[88:91], v[176:191]
    ds_read_b64_tr_b16 v[80:81], v10 offset:8704
    ds_read_b64_tr_b16 v[82:83], v10 offset:8960
    ds_read_b128 v[84:87], v9 offset:64
    ds_read_b128 v[88:91], v9 offset:576
    s_waitcnt lgkmcnt(8)
    v_mfma_f32_32x32x16_bf16 v[160:175], v[92:95], v[96:99], v[160:175]
    v_mfma_f32_32x32x16_bf16 v[176:191], v[92:95], v[100:103], v[176:191]
    ds_read_b64_tr_b16 v[92:93], v10 offset:13056
    ds_read_b64_tr_b16 v[94:95], v10 offset:13312
    ds_read_b128 v[96:99], v9 offset:96
    ds_read_b128 v[100:103], v9 offset:608
    s_waitcnt lgkmcnt(8)
    v_mfma_f32_32x32x16_bf16 v[160:175], v[104:107], v[108:111], v[160:175]
    v_mfma_f32_32x32x16_bf16 v[176:191], v[104:107], v[112:115], v[176:191]
    s_waitcnt lgkmcnt(0)
    s_barrier
    v_add_u32 v9, 51456, v7
    v_add_u32 v10, 59776, v8
    ds_read_b64_tr_b16 v[104:105], v10 offset:0
    ds_read_b64_tr_b16 v[106:107], v10 offset:256
    ds_read_b128 v[108:111], v9 offset:0
    ds_read_b128 v[112:115], v9 offset:512
    v_mfma_f32_32x32x16_bf16 v[160:175], v[80:83], v[84:87], v[160:175]
    v_mfma_f32_32x32x16_bf16 v[176:191], v[80:83], v[88:91], v[176:191]
    ds_read_b64_tr_b16 v[80:81], v10 offset:4352
    ds_read_b64_tr_b16 v[82:83], v10 offset:4608
    ds_read_b128 v[84:87], v9 offset:32
    ds_read_b128 v[88:91], v9 offset:544
    v_mfma_f32_32x32x16_bf16 v[160:175], v[92:95], v[96:99], v[160:175]
    v_mfma_f32_32x32x16_bf16 v[176:191], v[92:95], v[100:103], v[176:191]
    ds_read_b64_tr_b16 v[92:93], v10 offset:8704
    ds_read_b64_tr_b16 v[94:95], v10 offset:8960
    ds_read_b128 v[96:99], v9 offset:64
    ds_read_b128 v[100:103], v9 offset:576
    s_waitcnt lgkmcnt(8)
    v_mfma_f32_32x32x16_bf16 v[160:175], v[104:107], v[108:111], v[160:175]
    v_mfma_f32_32x32x16_bf16 v[176:191], v[104:107], v[112:115], v[176:191]
    ds_read_b64_tr_b16 v[104:105], v10 offset:13056
    ds_read_b64_tr_b16 v[106:107], v10 offset:13312
    ds_read_b128 v[108:111], v9 offset:96
    ds_read_b128 v[112:115], v9 offset:608
    s_waitcnt lgkmcnt(8)
    v_mfma_f32_32x32x16_bf16 v[160:175], v[80:83], v[84:87], v[160:175]
    v_mfma_f32_32x32x16_bf16 v[176:191], v[80:83], v[88:91], v[176:191]
    s_waitcnt lgkmcnt(0)
    s_barrier
    v_add_u32 v9, 0, v7
    v_add_u32 v10, 8320, v8
    ds_read_b64_tr_b16 v[80:81], v10 offset:0
    ds_read_b64_tr_b16 v[82:83], v10 offset:256
    ds_read_b128 v[84:87], v9 offset:0
    ds_read_b128 v[88:91], v9 offset:512
    v_mfma_f32_32x32x16_bf16 v[160:175], v[92:95], v[96:99], v[160:175]
    v_mfma_f32_32x32x16_bf16 v[176:191], v[92:95], v[100:103], v[176:191]
    ds_read_b64_tr_b16 v[92:93], v10 offset:4352
    ds_read_b64_tr_b16 v[94:95], v10 offset:4608
    ds_read_b128 v[96:99], v9 offset:32
    ds_read_b128 v[100:103], v9 offset:544
    v_mfma_f32_32x32x16_bf16 v[160:175], v[104:107], v[108:111], v[160:175]
    v_mfma_f32_32x32x16_bf16 v[176:191], v[104:107], v[112:115], v[176:191]
    ds_read_b64_tr_b16 v[104:105], v10 offset:8704
    ds_read_b64_tr_b16 v[106:107], v10 offset:8960
    ds_read_b128 v[108:111], v9 offset:64
    ds_read_b128 v[112:115], v9 offset:576
    s_waitcnt lgkmcnt(8)
    v_mfma_f32_32x32x16_bf16 v[160:175], v[80:83], v[84:87], v[160:175]
    v_mfma_f32_32x32x16_bf16 v[176:191], v[80:83], v[88:91], v[176:191]
    ds_read_b64_tr_b16 v[80:81], v10 offset:13056
    ds_read_b64_tr_b16 v[82:83], v10 offset:13312
    ds_read_b128 v[84:87], v9 offset:96
    ds_read_b128 v[88:91], v9 offset:608
    s_waitcnt lgkmcnt(8)
    v_mfma_f32_32x32x16_bf16 v[160:175], v[92:95], v[96:99], v[160:175]
    v_mfma_f32_32x32x16_bf16 v[176:191], v[92:95], v[100:103], v[176:191]
    s_waitcnt lgkmcnt(0)
    s_barrier
    v_add_u32 v9, 25728, v7
    v_add_u32 v10, 34048, v8
    ds_read_b64_tr_b16 v[92:93], v10 offset:0
    ds_read_b64_tr_b16 v[94:95], v10 offset:256
    ds_read_b128 v[96:99], v9 offset:0
    ds_read_b128 v[100:103], v9 offset:512
    v_mfma_f32_32x32x16_bf16 v[160:175], v[104:107], v[108:111], v[160:175]
    v_mfma_f32_32x32x16_bf16 v[176:191], v[104:107], v[112:115], v[176:191]
    ds_read_b64_tr_b16 v[104:105], v10 offset:4352
    ds_read_b64_tr_b16 v[106:107], v10 offset:4608
    ds_read_b128 v[108:111], v9 offset:32
    ds_read_b128 v[112:115], v9 offset:544
    v_mfma_f32_32x32x16_bf16 v[160:175], v[80:83], v[84:87], v[160:175]
    v_mfma_f32_32x32x16_bf16 v[176:191], v[80:83], v[88:91], v[176:191]
    ds_read_b64_tr_b16 v[80:81], v10 offset:8704
    ds_read_b64_tr_b16 v[82:83], v10 offset:8960
    ds_read_b128 v[84:87], v9 offset:64
    ds_read_b128 v[88:91], v9 offset:576
    s_waitcnt lgkmcnt(8)
    v_mfma_f32_32x32x16_bf16 v[160:175], v[92:95], v[96:99], v[160:175]
    v_mfma_f32_32x32x16_bf16 v[176:191], v[92:95], v[100:103], v[176:191]
    ds_read_b64_tr_b16 v[92:93], v10 offset:13056
    ds_read_b64_tr_b16 v[94:95], v10 offset:13312
    ds_read_b128 v[96:99], v9 offset:96
    ds_read_b128 v[100:103], v9 offset:608
    s_waitcnt lgkmcnt(8)
    v_mfma_f32_32x32x16_bf16 v[160:175], v[104:107], v[108:111], v[160:175]
    v_mfma_f32_32x32x16_bf16 v[176:191], v[104:107], v[112:115], v[176:191]
    s_waitcnt lgkmcnt(0)
    s_barrier
    v_add_u32 v9, 51456, v7
    v_add_u32 v10, 59776, v8
    ds_read_b64_tr_b16 v[104:105], v10 offset:0
    ds_read_b64_tr_b16 v[106:107], v10 offset:256
    ds_read_b128 v[108:111], v9 offset:0
    ds_read_b128 v[112:115], v9 offset:512
    v_mfma_f32_32x32x16_bf16 v[160:175], v[80:83], v[84:87], v[160:175]
    v_mfma_f32_32x32x16_bf16 v[176:191], v[80:83], v[88:91], v[176:191]
    ds_read_b64_tr_b16 v[80:81], v10 offset:4352
    ds_read_b64_tr_b16 v[82:83], v10 offset:4608
    ds_read_b128 v[84:87], v9 offset:32
    ds_read_b128 v[88:91], v9 offset:544
    v_mfma_f32_32x32x16_bf16 v[160:175], v[92:95], v[96:99], v[160:175]
    v_mfma_f32_32x32x16_bf16 v[176:191], v[92:95], v[100:103], v[176:191]
    ds_read_b64_tr_b16 v[92:93], v10 offset:8704
    ds_read_b64_tr_b16 v[94:95], v10 offset:8960
    ds_read_b128 v[96:99], v9 offset:64
    ds_read_b128 v[100:103], v9 offset:576
    s_waitcnt lgkmcnt(8)
    v_mfma_f32_32x32x16_bf16 v[160:175], v[104:107], v[108:111], v[160:175]
    v_mfma_f32_32x32x16_bf16 v[176:191], v[104:107], v[112:115], v[176:191]
    ds_read_b64_tr_b16 v[104:105], v10 offset:13056
    ds_read_b64_tr_b16 v[106:107], v10 offset:13312
    ds_read_b128 v[108:111], v9 offset:96
    ds_read_b128 v[112:115], v9 offset:608
    s_waitcnt lgkmcnt(8)
    v_mfma_f32_32x32x16_bf16 v[160:175], v[80:83], v[84:87], v[160:175]
    v_mfma_f32_32x32x16_bf16 v[176:191], v[80:83], v[88:91], v[176:191]
    s_waitcnt lgkmcnt(0)
    s_barrier
    v_add_u32 v9, 0, v7
    v_add_u32 v10, 8320, v8
    ds_read_b64_tr_b16 v[80:81], v10 offset:0
    ds_read_b64_tr_b16 v[82:83], v10 offset:256
    ds_read_b128 v[84:87], v9 offset:0
    ds_read_b128 v[88:91], v9 offset:512
    v_mfma_f32_32x32x16_bf16 v[160:175], v[92:95], v[96:99], v[160:175]
    v_mfma_f32_32x32x16_bf16 v[176:191], v[92:95], v[100:103], v[176:191]
    ds_read_b64_tr_b16 v[92:93], v10 offset:4352
    ds_read_b64_tr_b16 v[94:95], v10 offset:4608
    ds_read_b128 v[96:99], v9 offset:32
    ds_read_b128 v[100:103], v9 offset:544
    v_mfma_f32_32x32x16_bf16 v[160:175], v[104:107], v[108:111], v[160:175]
    v_mfma_f32_32x32x16_bf16 v[176:191], v[104:107], v[112:115], v[176:191]
    ds_read_b64_tr_b16 v[104:105], v10 offset:8704
    ds_read_b64_tr_b16 v[106:107], v10 offset:8960
    ds_read_b128 v[108:111], v9 offset:64
    ds_read_b128 v[112:115], v9 offset:576
    s_waitcnt lgkmcnt(8)
    v_mfma_f32_32x32x16_bf16 v[160:175], v[80:83], v[84:87], v[160:175]
    v_mfma_f32_32x32x16_bf16 v[176:191], v[80:83], v[88:91], v[176:191]
    ds_read_b64_tr_b16 v[80:81], v10 offset:13056
    ds_read_b64_tr_b16 v[82:83], v10 offset:13312
    ds_read_b128 v[84:87], v9 offset:96
    ds_read_b128 v[88:91], v9 offset:608
    s_waitcnt lgkmcnt(8)
    v_mfma_f32_32x32x16_bf16 v[160:175], v[92:95], v[96:99], v[160:175]
    v_mfma_f32_32x32x16_bf16 v[176:191], v[92:95], v[100:103], v[176:191]
    s_waitcnt lgkmcnt(0)
    s_barrier
    v_add_u32 v9, 25728, v7
    v_add_u32 v10, 34048, v8
    ds_read_b64_tr_b16 v[92:93], v10 offset:0
    ds_read_b64_tr_b16 v[94:95], v10 offset:256
    ds_read_b128 v[96:99], v9 offset:0
    ds_read_b128 v[100:103], v9 offset:512
    v_mfma_f32_32x32x16_bf16 v[160:175], v[104:107], v[108:111], v[160:175]
    v_mfma_f32_32x32x16_bf16 v[176:191], v[104:107], v[112:115], v[176:191]
    ds_read_b64_tr_b16 v[104:105], v10 offset:4352
    ds_read_b64_tr_b16 v[106:107], v10 offset:4608
    ds_read_b128 v[108:111], v9 offset:32
    ds_read_b128 v[112:115], v9 offset:544
    v_mfma_f32_32x32x16_bf16 v[160:175], v[80:83], v[84:87], v[160:175]
    v_mfma_f32_32x32x16_bf16 v[176:191], v[80:83], v[88:91], v[176:191]
    ds_read_b64_tr_b16 v[80:81], v10 offset:8704
    ds_read_b64_tr_b16 v[82:83], v10 offset:8960
    ds_read_b128 v[84:87], v9 offset:64
    ds_read_b128 v[88:91], v9 offset:576
    s_waitcnt lgkmcnt(8)
    v_mfma_f32_32x32x16_bf16 v[160:175], v[92:95], v[96:99], v[160:175]
    v_mfma_f32_32x32x16_bf16 v[176:191], v[92:95], v[100:103], v[176:191]
    ds_read_b64_tr_b16 v[92:93], v10 offset:13056
    ds_read_b64_tr_b16 v[94:95], v10 offset:13312
    ds_read_b128 v[96:99], v9 offset:96
    ds_read_b128 v[100:103], v9 offset:608
    s_waitcnt lgkmcnt(8)
    v_mfma_f32_32x32x16_bf16 v[160:175], v[104:107], v[108:111], v[160:175]
    v_mfma_f32_32x32x16_bf16 v[176:191], v[104:107], v[112:115], v[176:191]
    s_waitcnt lgkmcnt(4)
    v_mfma_f32_32x32x16_bf16 v[160:175], v[80:83], v[84:87], v[160:175]
    v_mfma_f32_32x32x16_bf16 v[176:191], v[80:83], v[88:91], v[176:191]
    s_waitcnt lgkmcnt(0)
    v_mfma_f32_32x32x16_bf16 v[160:175], v[92:95], v[96:99], v[160:175]
    v_mfma_f32_32x32x16_bf16 v[176:191], v[92:95], v[100:103], v[176:191]
    s_lshl_b32 s56, s40, 12
    s_add_u32 s56, s56, 129408
    v_add_u32 v21, s56, v5
    s_nop 7
    v_cvt_pk_bf16_f32 v64, v160, v161
    v_cvt_pk_bf16_f32 v65, v162, v163
    v_cvt_pk_bf16_f32 v66, v164, v165
    v_cvt_pk_bf16_f32 v67, v166, v167
    ds_write_b128 v21, v[64:67] offset:0
    v_cvt_pk_bf16_f32 v68, v168, v169
    v_cvt_pk_bf16_f32 v69, v170, v171
    v_cvt_pk_bf16_f32 v70, v172, v173
    v_cvt_pk_bf16_f32 v71, v174, v175
    ds_write_b128 v21, v[68:71] offset:2048
    v_cvt_pk_bf16_f32 v72, v176, v177
    v_cvt_pk_bf16_f32 v73, v178, v179
    v_cvt_pk_bf16_f32 v74, v180, v181
    v_cvt_pk_bf16_f32 v75, v182, v183
    ds_write_b128 v21, v[72:75] offset:1024
    v_cvt_pk_bf16_f32 v76, v184, v185
    v_cvt_pk_bf16_f32 v77, v186, v187
    v_cvt_pk_bf16_f32 v78, v188, v189
    v_cvt_pk_bf16_f32 v79, v190, v191
    ds_write_b128 v21, v[76:79] offset:3072
    s_waitcnt lgkmcnt(0)
    s_barrier
    v_add_u32 v21, 129408, v5
    v_add_u32 v13, s49, v11
    v_add_u32 v14, s49, v12
    ds_read_b128 v[32:35], v13 offset:0
    ds_read_b128 v[192:195], v21 offset:0
    ds_read_b128 v[196:199], v21 offset:1024
    ds_read_b128 v[36:39], v13 offset:32
    ds_read_b128 v[200:203], v21 offset:2048
    ds_read_b128 v[204:207], v21 offset:3072
    ds_read_b128 v[40:43], v13 offset:64
    ds_read_b128 v[208:211], v21 offset:4096
    ds_read_b128 v[212:215], v21 offset:5120
    ds_read_b128 v[44:47], v13 offset:96
    ds_read_b128 v[216:219], v21 offset:6144
    ds_read_b128 v[220:223], v21 offset:7168
    s_waitcnt lgkmcnt(9)
    v_mfma_f32_32x32x16_bf16 v[64:79], v[32:35], v[192:195], 0
    v_mfma_f32_32x32x16_bf16 v[80:95], v[32:35], v[196:199], 0
    ds_read_b128 v[32:35], v14 offset:128
    ds_read_b128 v[224:227], v21 offset:8192
    ds_read_b128 v[228:231], v21 offset:9216
    s_waitcnt lgkmcnt(9)
    v_mfma_f32_32x32x16_bf16 v[64:79], v[36:39], v[200:203], v[64:79]
    v_mfma_f32_32x32x16_bf16 v[80:95], v[36:39], v[204:207], v[80:95]
    ds_read_b128 v[36:39], v14 offset:160
    ds_read_b128 v[232:235], v21 offset:10240
    ds_read_b128 v[236:239], v21 offset:11264
    s_waitcnt lgkmcnt(9)
    v_mfma_f32_32x32x16_bf16 v[64:79], v[40:43], v[208:211], v[64:79]
    v_mfma_f32_32x32x16_bf16 v[80:95], v[40:43], v[212:215], v[80:95]
    ds_read_b128 v[40:43], v14 offset:192
    ds_read_b128 v[240:243], v21 offset:12288
    ds_read_b128 v[244:247], v21 offset:13312
    s_waitcnt lgkmcnt(9)
    v_mfma_f32_32x32x16_bf16 v[64:79], v[44:47], v[216:219], v[64:79]
    v_mfma_f32_32x32x16_bf16 v[80:95], v[44:47], v[220:223], v[80:95]
    ds_read_b128 v[44:47], v14 offset:224
    ds_read_b128 v[248:251], v21 offset:14336
    ds_read_b128 v[252:255], v21 offset:15360
    s_waitcnt lgkmcnt(9)
    v_mfma_f32_32x32x16_bf16 v[64:79], v[32:35], v[224:227], v[64:79]
    v_mfma_f32_32x32x16_bf16 v[80:95], v[32:35], v[228:231], v[80:95]
    v_add_u32 v13, s50, v11
    v_add_u32 v14, s50, v12
    ds_read_b128 v[32:35], v13 offset:0
    s_waitcnt lgkmcnt(7)
    v_mfma_f32_32x32x16_bf16 v[64:79], v[36:39], v[232:235], v[64:79]
    v_mfma_f32_32x32x16_bf16 v[80:95], v[36:39], v[236:239], v[80:95]
    ds_read_b128 v[36:39], v13 offset:32
    s_waitcnt lgkmcnt(5)
    v_mfma_f32_32x32x16_bf16 v[64:79], v[40:43], v[240:243], v[64:79]
    v_mfma_f32_32x32x16_bf16 v[80:95], v[40:43], v[244:247], v[80:95]
    ds_read_b128 v[40:43], v13 offset:64
    s_waitcnt lgkmcnt(3)
    v_mfma_f32_32x32x16_bf16 v[64:79], v[44:47], v[248:251], v[64:79]
    v_mfma_f32_32x32x16_bf16 v[80:95], v[44:47], v[252:255], v[80:95]
    ds_read_b128 v[44:47], v13 offset:96
    s_waitcnt lgkmcnt(3)
    v_mfma_f32_32x32x16_bf16 v[96:111], v[32:35], v[192:195], 0
    v_mfma_f32_32x32x16_bf16 v[112:127], v[32:35], v[196:199], 0
    ds_read_b128 v[32:35], v14 offset:128
    s_waitcnt lgkmcnt(3)
    v_mfma_f32_32x32x16_bf16 v[96:111], v[36:39], v[200:203], v[96:111]
    v_mfma_f32_32x32x16_bf16 v[112:127], v[36:39], v[204:207], v[112:127]
    ds_read_b128 v[36:39], v14 offset:160
    s_waitcnt lgkmcnt(3)
    v_mfma_f32_32x32x16_bf16 v[96:111], v[40:43], v[208:211], v[96:111]
    v_max3_f32 v48, v64, v65, v66
    v_max3_f32 v48, v48, v67, v68
    v_mfma_f32_32x32x16_bf16 v[112:127], v[40:43], v[212:215], v[112:127]
    v_max3_f32 v48, v48, v69, v70
    v_max3_f32 v48, v48, v71, v72
    ds_read_b128 v[40:43], v14 offset:192
    s_waitcnt lgkmcnt(3)
    v_mfma_f32_32x32x16_bf16 v[96:111], v[44:47], v[216:219], v[96:111]
    v_max3_f32 v48, v48, v73, v74
    v_max3_f32 v48, v48, v75, v76
    v_mfma_f32_32x32x16_bf16 v[112:127], v[44:47], v[220:223], v[112:127]
    v_max3_f32 v48, v48, v77, v78
    v_max_f32 v48, v48, v79
    ds_read_b128 v[44:47], v14 offset:224
    s_waitcnt lgkmcnt(3)
    v_mfma_f32_32x32x16_bf16 v[96:111], v[32:35], v[224:227], v[96:111]
    v_max3_f32 v49, v80, v81, v82
    v_max3_f32 v49, v49, v83, v84
    v_mfma_f32_32x32x16_bf16 v[112:127], v[32:35], v[228:231], v[112:127]
    v_max3_f32 v49, v49, v85, v86
    v_max3_f32 v49, v49, v87, v88
    s_waitcnt lgkmcnt(0)
    s_barrier
    v_add_u32 v13, s51, v11
    v_add_u32 v14, s51, v12
    ds_read_b128 v[32:35], v13 offset:0
    v_mfma_f32_32x32x16_bf16 v[96:111], v[36:39], v[232:235], v[96:111]
    v_max3_f32 v49, v49, v89, v90
    v_max3_f32 v49, v49, v91, v92
    v_mfma_f32_32x32x16_bf16 v[112:127], v[36:39], v[236:239], v[112:127]
    v_max3_f32 v49, v49, v93, v94
    v_max_f32 v49, v49, v95
    ds_read_b128 v[36:39], v13 offset:32
    v_mfma_f32_32x32x16_bf16 v[96:111], v[40:43], v[240:243], v[96:111]
    v_mfma_f32_32x32x16_bf16 v[112:127], v[40:43], v[244:247], v[112:127]
    ds_read_b128 v[40:43], v13 offset:64
    v_mfma_f32_32x32x16_bf16 v[96:111], v[44:47], v[248:251], v[96:111]
    v_mfma_f32_32x32x16_bf16 v[112:127], v[44:47], v[252:255], v[112:127]
    ds_read_b128 v[44:47], v13 offset:96
    s_waitcnt lgkmcnt(3)
    v_mfma_f32_32x32x16_bf16 v[128:143], v[32:35], v[192:195], 0
    v_mfma_f32_32x32x16_bf16 v[144:159], v[32:35], v[196:199], 0
    ds_read_b128 v[32:35], v14 offset:128
    s_waitcnt lgkmcnt(3)
    v_mfma_f32_32x32x16_bf16 v[128:143], v[36:39], v[200:203], v[128:143]
    v_mfma_f32_32x32x16_bf16 v[144:159], v[36:39], v[204:207], v[144:159]
    ds_read_b128 v[36:39], v14 offset:160
    s_waitcnt lgkmcnt(3)
    v_mfma_f32_32x32x16_bf16 v[128:143], v[40:43], v[208:211], v[128:143]
    v_max3_f32 v48, v48, v96, v97
    v_max3_f32 v48, v48, v98, v99
    v_mfma_f32_32x32x16_bf16 v[144:159], v[40:43], v[212:215], v[144:159]
    v_max3_f32 v48, v48, v100, v101
    v_max3_f32 v48, v48, v102, v103
    ds_read_b128 v[40:43], v14 offset:192
    s_waitcnt lgkmcnt(3)
    v_mfma_f32_32x32x16_bf16 v[128:143], v[44:47], v[216:219], v[128:143]
    v_max3_f32 v48, v48, v104, v105
    v_max3_f32 v48, v48, v106, v107
    v_mfma_f32_32x32x16_bf16 v[144:159], v[44:47], v[220:223], v[144:159]
    v_max3_f32 v48, v48, v108, v109
    v_max3_f32 v48, v48, v110, v111
    ds_read_b128 v[44:47], v14 offset:224
    s_waitcnt lgkmcnt(3)
    v_mfma_f32_32x32x16_bf16 v[128:143], v[32:35], v[224:227], v[128:143]
    v_max3_f32 v49, v49, v112, v113
    v_max3_f32 v49, v49, v114, v115
    v_mfma_f32_32x32x16_bf16 v[144:159], v[32:35], v[228:231], v[144:159]
    v_max3_f32 v49, v49, v116, v117
    v_max3_f32 v49, v49, v118, v119
    v_add_u32 v13, s52, v11
    v_add_u32 v14, s52, v12
    ds_read_b128 v[32:35], v13 offset:0
    s_waitcnt lgkmcnt(3)
    v_mfma_f32_32x32x16_bf16 v[128:143], v[36:39], v[232:235], v[128:143]
    v_max3_f32 v49, v49, v120, v121
    v_max3_f32 v49, v49, v122, v123
    v_mfma_f32_32x32x16_bf16 v[144:159], v[36:39], v[236:239], v[144:159]
    v_max3_f32 v49, v49, v124, v125
    v_max3_f32 v49, v49, v126, v127
    ds_read_b128 v[36:39], v13 offset:32
    s_waitcnt lgkmcnt(3)
    v_mfma_f32_32x32x16_bf16 v[128:143], v[40:43], v[240:243], v[128:143]
    v_mfma_f32_32x32x16_bf16 v[144:159], v[40:43], v[244:247], v[144:159]
    ds_read_b128 v[40:43], v13 offset:64
    s_waitcnt lgkmcnt(3)
    v_mfma_f32_32x32x16_bf16 v[128:143], v[44:47], v[248:251], v[128:143]
    v_mfma_f32_32x32x16_bf16 v[144:159], v[44:47], v[252:255], v[144:159]
    ds_read_b128 v[44:47], v13 offset:96
    s_waitcnt lgkmcnt(3)
    v_mfma_f32_32x32x16_bf16 v[160:175], v[32:35], v[192:195], 0
    v_mfma_f32_32x32x16_bf16 v[176:191], v[32:35], v[196:199], 0
    ds_read_b128 v[32:35], v14 offset:128
    s_waitcnt lgkmcnt(3)
    v_mfma_f32_32x32x16_bf16 v[160:175], v[36:39], v[200:203], v[160:175]
    v_mfma_f32_32x32x16_bf16 v[176:191], v[36:39], v[204:207], v[176:191]
    ds_read_b128 v[36:39], v14 offset:160
    s_waitcnt lgkmcnt(3)
    v_mfma_f32_32x32x16_bf16 v[160:175], v[40:43], v[208:211], v[160:175]
    v_max3_f32 v48, v48, v128, v129
    v_max3_f32 v48, v48, v130, v131
    v_mfma_f32_32x32x16_bf16 v[176:191], v[40:43], v[212:215], v[176:191]
    v_max3_f32 v48, v48, v132, v133
    v_max3_f32 v48, v48, v134, v135
    ds_read_b128 v[40:43], v14 offset:192
    s_waitcnt lgkmcnt(3)
    v_mfma_f32_32x32x16_bf16 v[160:175], v[44:47], v[216:219], v[160:175]
    v_max3_f32 v48, v48, v136, v137
    v_max3_f32 v48, v48, v138, v139
    v_mfma_f32_32x32x16_bf16 v[176:191], v[44:47], v[220:223], v[176:191]
    v_max3_f32 v48, v48, v140, v141
    v_max3_f32 v48, v48, v142, v143
    ds_read_b128 v[44:47], v14 offset:224
    s_waitcnt lgkmcnt(3)
    v_mfma_f32_32x32x16_bf16 v[160:175], v[32:35], v[224:227], v[160:175]
    v_max3_f32 v49, v49, v144, v145
    v_max3_f32 v49, v49, v146, v147
    v_mfma_f32_32x32x16_bf16 v[176:191], v[32:35], v[228:231], v[176:191]
    v_max3_f32 v49, v49, v148, v149
    v_max3_f32 v49, v49, v150, v151
    s_waitcnt lgkmcnt(2)
    v_mfma_f32_32x32x16_bf16 v[160:175], v[36:39], v[232:235], v[160:175]
    v_max3_f32 v49, v49, v152, v153
    v_max3_f32 v49, v49, v154, v155
    v_mfma_f32_32x32x16_bf16 v[176:191], v[36:39], v[236:239], v[176:191]
    v_max3_f32 v49, v49, v156, v157
    v_max3_f32 v49, v49, v158, v159
    s_waitcnt lgkmcnt(1)
    v_mfma_f32_32x32x16_bf16 v[160:175], v[40:43], v[240:243], v[160:175]
    v_mfma_f32_32x32x16_bf16 v[176:191], v[40:43], v[244:247], v[176:191]
    s_waitcnt lgkmcnt(0)
    v_mfma_f32_32x32x16_bf16 v[160:175], v[44:47], v[248:251], v[160:175]
    v_mfma_f32_32x32x16_bf16 v[176:191], v[44:47], v[252:255], v[176:191]
    s_lshl_b32 s56, s40, 8
    s_add_u32 s56, s56, 69632
    v_add_u32 v22, s56, v20
    v_add_u32 v23, 69632, v20
    s_nop 6
    v_max3_f32 v48, v48, v160, v161
    v_max3_f32 v48, v48, v162, v163
    v_max3_f32 v48, v48, v164, v165
    v_max3_f32 v48, v48, v166, v167
    v_max3_f32 v48, v48, v168, v169
    v_max3_f32 v48, v48, v170, v171
    v_max3_f32 v48, v48, v172, v173
    v_max3_f32 v48, v48, v174, v175
    v_max3_f32 v49, v49, v176, v177
    v_max3_f32 v49, v49, v178, v179
    v_max3_f32 v49, v49, v180, v181
    v_max3_f32 v49, v49, v182, v183
    v_max3_f32 v49, v49, v184, v185
    v_max3_f32 v49, v49, v186, v187
    v_max3_f32 v49, v49, v188, v189
    v_max3_f32 v49, v49, v190, v191
    v_mov_b32 v52, v48
    v_mov_b32 v53, v49
    s_nop 0
    v_permlane32_swap_b32 v48, v52
    v_permlane32_swap_b32 v49, v53
    v_max_f32 v48, v48, v52
    v_max_f32 v49, v49, v53
    ds_write_b32 v22, v48 offset:0
    ds_write_b32 v22, v49 offset:128
    s_waitcnt lgkmcnt(0)
    s_barrier
    ds_read_b32 v52, v23 offset:0
    ds_read_b32 v53, v23 offset:256
    ds_read_b32 v54, v23 offset:512
    ds_read_b32 v55, v23 offset:768
    ds_read_b32 v56, v23 offset:128
    ds_read_b32 v57, v23 offset:384
    ds_read_b32 v58, v23 offset:640
    ds_read_b32 v59, v23 offset:896
    s_waitcnt lgkmcnt(0)
    v_max3_f32 v48, v52, v53, v54
    v_max_f32 v48, v48, v55
    v_max3_f32 v49, v56, v57, v58
    v_max_f32 v49, v49, v59
    v_mul_f32 v48, s68, v48
    v_mul_f32 v49, s68, v49
    v_fma_f32 v64, v64, s68, -v48
    v_fma_f32 v65, v65, s68, -v48
    v_fma_f32 v66, v66, s68, -v48
    v_fma_f32 v67, v67, s68, -v48
    v_fma_f32 v68, v68, s68, -v48
    v_fma_f32 v69, v69, s68, -v48
    v_fma_f32 v70, v70, s68, -v48
    v_fma_f32 v71, v71, s68, -v48
    v_exp_f32 v64, v64
    v_exp_f32 v65, v65
    v_exp_f32 v66, v66
    v_exp_f32 v67, v67
    v_exp_f32 v68, v68
    v_exp_f32 v69, v69
    v_exp_f32 v70, v70
    v_exp_f32 v71, v71
    v_mov_b32 v32, v64
    v_mov_b32 v33, v65
    v_mov_b32 v34, v66
    v_mov_b32 v35, v67
    v_add_f32 v32, v32, v68
    v_add_f32 v33, v33, v69
    v_add_f32 v34, v34, v70
    v_add_f32 v35, v35, v71
    v_cvt_pk_bf16_f32 v64, v64, v65
    v_cvt_pk_bf16_f32 v65, v66, v67
    v_cvt_pk_bf16_f32 v66, v68, v69
    v_cvt_pk_bf16_f32 v67, v70, v71
    ds_write_b128 v16, v[64:67] offset:0
    v_fma_f32 v72, v72, s68, -v48
    v_fma_f32 v73, v73, s68, -v48
    v_fma_f32 v74, v74, s68, -v48
    v_fma_f32 v75, v75, s68, -v48
    v_fma_f32 v76, v76, s68, -v48
    v_fma_f32 v77, v77, s68, -v48
    v_fma_f32 v78, v78, s68, -v48
    v_fma_f32 v79, v79, s68, -v48
    v_exp_f32 v72, v72
    v_exp_f32 v73, v73
    v_exp_f32 v74, v74
    v_exp_f32 v75, v75
    v_exp_f32 v76, v76
    v_exp_f32 v77, v77
    v_exp_f32 v78, v78
    v_exp_f32 v79, v79
    v_add_f32 v32, v32, v72
    v_add_f32 v33, v33, v73
    v_add_f32 v34, v34, v74
    v_add_f32 v35, v35, v75
    v_add_f32 v32, v32, v76
    v_add_f32 v33, v33, v77
    v_add_f32 v34, v34, v78
    v_add_f32 v35, v35, v79
    v_cvt_pk_bf16_f32 v68, v72, v73
    v_cvt_pk_bf16_f32 v69, v74, v75
    v_cvt_pk_bf16_f32 v70, v76, v77
    v_cvt_pk_bf16_f32 v71, v78, v79
    ds_write_b128 v16, v[68:71] offset:1024
    v_fma_f32 v80, v80, s68, -v49
    v_fma_f32 v81, v81, s68, -v49
    v_fma_f32 v82, v82, s68, -v49
    v_fma_f32 v83, v83, s68, -v49
    v_fma_f32 v84, v84, s68, -v49
    v_fma_f32 v85, v85, s68, -v49
    v_fma_f32 v86, v86, s68, -v49
    v_fma_f32 v87, v87, s68, -v49
    v_exp_f32 v80, v80
    v_exp_f32 v81, v81
    v_exp_f32 v82, v82
    v_exp_f32 v83, v83
    v_exp_f32 v84, v84
    v_exp_f32 v85, v85
    v_exp_f32 v86, v86
    v_exp_f32 v87, v87
    v_mov_b32 v36, v80
    v_mov_b32 v37, v81
    v_mov_b32 v38, v82
    v_mov_b32 v39, v83
    v_add_f32 v36, v36, v84
    v_add_f32 v37, v37, v85
    v_add_f32 v38, v38, v86
    v_add_f32 v39, v39, v87
    v_cvt_pk_bf16_f32 v80, v80, v81
    v_cvt_pk_bf16_f32 v81, v82, v83
    v_cvt_pk_bf16_f32 v82, v84, v85
    v_cvt_pk_bf16_f32 v83, v86, v87
    ds_write_b128 v16, v[80:83] offset:2048
    v_fma_f32 v88, v88, s68, -v49
    v_fma_f32 v89, v89, s68, -v49
    v_fma_f32 v90, v90, s68, -v49
    v_fma_f32 v91, v91, s68, -v49
    v_fma_f32 v92, v92, s68, -v49
    v_fma_f32 v93, v93, s68, -v49
    v_fma_f32 v94, v94, s68, -v49
    v_fma_f32 v95, v95, s68, -v49
    v_exp_f32 v88, v88
    v_exp_f32 v89, v89
    v_exp_f32 v90, v90
    v_exp_f32 v91, v91
    v_exp_f32 v92, v92
    v_exp_f32 v93, v93
    v_exp_f32 v94, v94
    v_exp_f32 v95, v95
    v_add_f32 v36, v36, v88
    v_add_f32 v37, v37, v89
    v_add_f32 v38, v38, v90
    v_add_f32 v39, v39, v91
    v_add_f32 v36, v36, v92
    v_add_f32 v37, v37, v93
    v_add_f32 v38, v38, v94
    v_add_f32 v39, v39, v95
    v_cvt_pk_bf16_f32 v84, v88, v89
    v_cvt_pk_bf16_f32 v85, v90, v91
    v_cvt_pk_bf16_f32 v86, v92, v93
    v_cvt_pk_bf16_f32 v87, v94, v95
    ds_write_b128 v16, v[84:87] offset:3072
    s_waitcnt lgkmcnt(0)
    s_barrier
    v_fma_f32 v96, v96, s68, -v48
    v_fma_f32 v97, v97, s68, -v48
    v_fma_f32 v98, v98, s68, -v48
    v_fma_f32 v99, v99, s68, -v48
    v_fma_f32 v100, v100, s68, -v48
    v_fma_f32 v101, v101, s68, -v48
    v_fma_f32 v102, v102, s68, -v48
    v_fma_f32 v103, v103, s68, -v48
    v_exp_f32 v96, v96
    v_exp_f32 v97, v97
    v_exp_f32 v98, v98
    v_exp_f32 v99, v99
    v_exp_f32 v100, v100
    v_exp_f32 v101, v101
    v_exp_f32 v102, v102
    v_exp_f32 v103, v103
    v_add_f32 v32, v32, v96
    v_add_f32 v33, v33, v97
    v_add_f32 v34, v34, v98
    v_add_f32 v35, v35, v99
    v_add_f32 v32, v32, v100
    v_add_f32 v33, v33, v101
    v_add_f32 v34, v34, v102
    v_add_f32 v35, v35, v103
    v_cvt_pk_bf16_f32 v96, v96, v97
    v_cvt_pk_bf16_f32 v97, v98, v99
    v_cvt_pk_bf16_f32 v98, v100, v101
    v_cvt_pk_bf16_f32 v99, v102, v103
    ds_write_b128 v16, v[96:99] offset:16384
    v_fma_f32 v104, v104, s68, -v48
    v_fma_f32 v105, v105, s68, -v48
    v_fma_f32 v106, v106, s68, -v48
    v_fma_f32 v107, v107, s68, -v48
    v_fma_f32 v108, v108, s68, -v48
    v_fma_f32 v109, v109, s68, -v48
    v_fma_f32 v110, v110, s68, -v48
    v_fma_f32 v111, v111, s68, -v48
    v_exp_f32 v104, v104
    v_exp_f32 v105, v105
    v_exp_f32 v106, v106
    v_exp_f32 v107, v107
    v_exp_f32 v108, v108
    v_exp_f32 v109, v109
    v_exp_f32 v110, v110
    v_exp_f32 v111, v111
    v_add_f32 v32, v32, v104
    v_add_f32 v33, v33, v105
    v_add_f32 v34, v34, v106
    v_add_f32 v35, v35, v107
    v_add_f32 v32, v32, v108
    v_add_f32 v33, v33, v109
    v_add_f32 v34, v34, v110
    v_add_f32 v35, v35, v111
    v_cvt_pk_bf16_f32 v100, v104, v105
    v_cvt_pk_bf16_f32 v101, v106, v107
    v_cvt_pk_bf16_f32 v102, v108, v109
    v_cvt_pk_bf16_f32 v103, v110, v111
    ds_write_b128 v16, v[100:103] offset:17408
    v_fma_f32 v112, v112, s68, -v49
    v_fma_f32 v113, v113, s68, -v49
    v_fma_f32 v114, v114, s68, -v49
    v_fma_f32 v115, v115, s68, -v49
    v_fma_f32 v116, v116, s68, -v49
    v_fma_f32 v117, v117, s68, -v49
    v_fma_f32 v118, v118, s68, -v49
    v_fma_f32 v119, v119, s68, -v49
    v_exp_f32 v112, v112
    v_exp_f32 v113, v113
    v_exp_f32 v114, v114
    v_exp_f32 v115, v115
    v_exp_f32 v116, v116
    v_exp_f32 v117, v117
    v_exp_f32 v118, v118
    v_exp_f32 v119, v119
    v_add_f32 v36, v36, v112
    v_add_f32 v37, v37, v113
    v_add_f32 v38, v38, v114
    v_add_f32 v39, v39, v115
    v_add_f32 v36, v36, v116
    v_add_f32 v37, v37, v117
    v_add_f32 v38, v38, v118
    v_add_f32 v39, v39, v119
    v_cvt_pk_bf16_f32 v112, v112, v113
    v_cvt_pk_bf16_f32 v113, v114, v115
    v_cvt_pk_bf16_f32 v114, v116, v117
    v_cvt_pk_bf16_f32 v115, v118, v119
    ds_write_b128 v16, v[112:115] offset:18432
    v_fma_f32 v120, v120, s68, -v49
    v_fma_f32 v121, v121, s68, -v49
    v_fma_f32 v122, v122, s68, -v49
    v_fma_f32 v123, v123, s68, -v49
    v_fma_f32 v124, v124, s68, -v49
    v_fma_f32 v125, v125, s68, -v49
    v_fma_f32 v126, v126, s68, -v49
    v_fma_f32 v127, v127, s68, -v49
    v_exp_f32 v120, v120
    v_exp_f32 v121, v121
    v_exp_f32 v122, v122
    v_exp_f32 v123, v123
    v_exp_f32 v124, v124
    v_exp_f32 v125, v125
    v_exp_f32 v126, v126
    v_exp_f32 v127, v127
    v_add_f32 v36, v36, v120
    v_add_f32 v37, v37, v121
    v_add_f32 v38, v38, v122
    v_add_f32 v39, v39, v123
    v_add_f32 v36, v36, v124
    v_add_f32 v37, v37, v125
    v_add_f32 v38, v38, v126
    v_add_f32 v39, v39, v127
    v_cvt_pk_bf16_f32 v116, v120, v121
    v_cvt_pk_bf16_f32 v117, v122, v123
    v_cvt_pk_bf16_f32 v118, v124, v125
    v_cvt_pk_bf16_f32 v119, v126, v127
    ds_write_b128 v16, v[116:119] offset:19456
    s_waitcnt lgkmcnt(0)
    s_barrier
    v_fma_f32 v128, v128, s68, -v48
    v_fma_f32 v129, v129, s68, -v48
    v_fma_f32 v130, v130, s68, -v48
    v_fma_f32 v131, v131, s68, -v48
    v_fma_f32 v132, v132, s68, -v48
    v_fma_f32 v133, v133, s68, -v48
    v_fma_f32 v134, v134, s68, -v48
    v_fma_f32 v135, v135, s68, -v48
    v_exp_f32 v128, v128
    v_exp_f32 v129, v129
    v_exp_f32 v130, v130
    v_exp_f32 v131, v131
    v_exp_f32 v132, v132
    v_exp_f32 v133, v133
    v_exp_f32 v134, v134
    v_exp_f32 v135, v135
    v_add_f32 v32, v32, v128
    v_add_f32 v33, v33, v129
    v_add_f32 v34, v34, v130
    v_add_f32 v35, v35, v131
    v_add_f32 v32, v32, v132
    v_add_f32 v33, v33, v133
    v_add_f32 v34, v34, v134
    v_add_f32 v35, v35, v135
    v_cvt_pk_bf16_f32 v128, v128, v129
    v_cvt_pk_bf16_f32 v129, v130, v131
    v_cvt_pk_bf16_f32 v130, v132, v133
    v_cvt_pk_bf16_f32 v131, v134, v135
    ds_write_b128 v16, v[128:131] offset:0
    v_fma_f32 v136, v136, s68, -v48
    v_fma_f32 v137, v137, s68, -v48
    v_fma_f32 v138, v138, s68, -v48
    v_fma_f32 v139, v139, s68, -v48
    v_fma_f32 v140, v140, s68, -v48
    v_fma_f32 v141, v141, s68, -v48
    v_fma_f32 v142, v142, s68, -v48
    v_fma_f32 v143, v143, s68, -v48
    v_exp_f32 v136, v136
    v_exp_f32 v137, v137
    v_exp_f32 v138, v138
    v_exp_f32 v139, v139
    v_exp_f32 v140, v140
    v_exp_f32 v141, v141
    v_exp_f32 v142, v142
    v_exp_f32 v143, v143
    v_add_f32 v32, v32, v136
    v_add_f32 v33, v33, v137
    v_add_f32 v34, v34, v138
    v_add_f32 v35, v35, v139
    v_add_f32 v32, v32, v140
    v_add_f32 v33, v33, v141
    v_add_f32 v34, v34, v142
    v_add_f32 v35, v35, v143
    v_cvt_pk_bf16_f32 v132, v136, v137
    v_cvt_pk_bf16_f32 v133, v138, v139
    v_cvt_pk_bf16_f32 v134, v140, v141
    v_cvt_pk_bf16_f32 v135, v142, v143
    ds_write_b128 v16, v[132:135] offset:1024
    v_fma_f32 v144, v144, s68, -v49
    v_fma_f32 v145, v145, s68, -v49
    v_fma_f32 v146, v146, s68, -v49
    v_fma_f32 v147, v147, s68, -v49
    v_fma_f32 v148, v148, s68, -v49
    v_fma_f32 v149, v149, s68, -v49
    v_fma_f32 v150, v150, s68, -v49
    v_fma_f32 v151, v151, s68, -v49
    v_exp_f32 v144, v144
    v_exp_f32 v145, v145
    v_exp_f32 v146, v146
    v_exp_f32 v147, v147
    v_exp_f32 v148, v148
    v_exp_f32 v149, v149
    v_exp_f32 v150, v150
    v_exp_f32 v151, v151
    v_add_f32 v36, v36, v144
    v_add_f32 v37, v37, v145
    v_add_f32 v38, v38, v146
    v_add_f32 v39, v39, v147
    v_add_f32 v36, v36, v148
    v_add_f32 v37, v37, v149
    v_add_f32 v38, v38, v150
    v_add_f32 v39, v39, v151
    v_cvt_pk_bf16_f32 v144, v144, v145
    v_cvt_pk_bf16_f32 v145, v146, v147
    v_cvt_pk_bf16_f32 v146, v148, v149
    v_cvt_pk_bf16_f32 v147, v150, v151
    ds_write_b128 v16, v[144:147] offset:2048
    v_fma_f32 v152, v152, s68, -v49
    v_fma_f32 v153, v153, s68, -v49
    v_fma_f32 v154, v154, s68, -v49
    v_fma_f32 v155, v155, s68, -v49
    v_fma_f32 v156, v156, s68, -v49
    v_fma_f32 v157, v157, s68, -v49
    v_fma_f32 v158, v158, s68, -v49
    v_fma_f32 v159, v159, s68, -v49
    v_exp_f32 v152, v152
    v_exp_f32 v153, v153
    v_exp_f32 v154, v154
    v_exp_f32 v155, v155
    v_exp_f32 v156, v156
    v_exp_f32 v157, v157
    v_exp_f32 v158, v158
    v_exp_f32 v159, v159
    v_add_f32 v36, v36, v152
    v_add_f32 v37, v37, v153
    v_add_f32 v38, v38, v154
    v_add_f32 v39, v39, v155
    v_add_f32 v36, v36, v156
    v_add_f32 v37, v37, v157
    v_add_f32 v38, v38, v158
    v_add_f32 v39, v39, v159
    v_cvt_pk_bf16_f32 v148, v152, v153
    v_cvt_pk_bf16_f32 v149, v154, v155
    v_cvt_pk_bf16_f32 v150, v156, v157
    v_cvt_pk_bf16_f32 v151, v158, v159
    ds_write_b128 v16, v[148:151] offset:3072
    s_waitcnt lgkmcnt(0)
    s_barrier
    v_fma_f32 v160, v160, s68, -v48
    v_fma_f32 v161, v161, s68, -v48
    v_fma_f32 v162, v162, s68, -v48
    v_fma_f32 v163, v163, s68, -v48
    v_fma_f32 v164, v164, s68, -v48
    v_fma_f32 v165, v165, s68, -v48
    v_fma_f32 v166, v166, s68, -v48
    v_fma_f32 v167, v167, s68, -v48
    v_exp_f32 v160, v160
    v_exp_f32 v161, v161
    v_exp_f32 v162, v162
    v_exp_f32 v163, v163
    v_exp_f32 v164, v164
    v_exp_f32 v165, v165
    v_exp_f32 v166, v166
    v_exp_f32 v167, v167
    v_add_f32 v32, v32, v160
    v_add_f32 v33, v33, v161
    v_add_f32 v34, v34, v162
    v_add_f32 v35, v35, v163
    v_add_f32 v32, v32, v164
    v_add_f32 v33, v33, v165
    v_add_f32 v34, v34, v166
    v_add_f32 v35, v35, v167
    v_cvt_pk_bf16_f32 v160, v160, v161
    v_cvt_pk_bf16_f32 v161, v162, v163
    v_cvt_pk_bf16_f32 v162, v164, v165
    v_cvt_pk_bf16_f32 v163, v166, v167
    ds_write_b128 v16, v[160:163] offset:16384
    v_fma_f32 v168, v168, s68, -v48
    v_fma_f32 v169, v169, s68, -v48
    v_fma_f32 v170, v170, s68, -v48
    v_fma_f32 v171, v171, s68, -v48
    v_fma_f32 v172, v172, s68, -v48
    v_fma_f32 v173, v173, s68, -v48
    v_fma_f32 v174, v174, s68, -v48
    v_fma_f32 v175, v175, s68, -v48
    v_exp_f32 v168, v168
    v_exp_f32 v169, v169
    v_exp_f32 v170, v170
    v_exp_f32 v171, v171
    v_exp_f32 v172, v172
    v_exp_f32 v173, v173
    v_exp_f32 v174, v174
    v_exp_f32 v175, v175
    v_add_f32 v32, v32, v168
    v_add_f32 v33, v33, v169
    v_add_f32 v34, v34, v170
    v_add_f32 v35, v35, v171
    v_add_f32 v32, v32, v172
    v_add_f32 v33, v33, v173
    v_add_f32 v34, v34, v174
    v_add_f32 v35, v35, v175
    v_cvt_pk_bf16_f32 v164, v168, v169
    v_cvt_pk_bf16_f32 v165, v170, v171
    v_cvt_pk_bf16_f32 v166, v172, v173
    v_cvt_pk_bf16_f32 v167, v174, v175
    ds_write_b128 v16, v[164:167] offset:17408
    v_fma_f32 v176, v176, s68, -v49
    v_fma_f32 v177, v177, s68, -v49
    v_fma_f32 v178, v178, s68, -v49
    v_fma_f32 v179, v179, s68, -v49
    v_fma_f32 v180, v180, s68, -v49
    v_fma_f32 v181, v181, s68, -v49
    v_fma_f32 v182, v182, s68, -v49
    v_fma_f32 v183, v183, s68, -v49
    v_exp_f32 v176, v176
    v_exp_f32 v177, v177
    v_exp_f32 v178, v178
    v_exp_f32 v179, v179
    v_exp_f32 v180, v180
    v_exp_f32 v181, v181
    v_exp_f32 v182, v182
    v_exp_f32 v183, v183
    v_add_f32 v36, v36, v176
    v_add_f32 v37, v37, v177
    v_add_f32 v38, v38, v178
    v_add_f32 v39, v39, v179
    v_add_f32 v36, v36, v180
    v_add_f32 v37, v37, v181
    v_add_f32 v38, v38, v182
    v_add_f32 v39, v39, v183
    v_cvt_pk_bf16_f32 v176, v176, v177
    v_cvt_pk_bf16_f32 v177, v178, v179
    v_cvt_pk_bf16_f32 v178, v180, v181
    v_cvt_pk_bf16_f32 v179, v182, v183
    ds_write_b128 v16, v[176:179] offset:18432
    v_fma_f32 v184, v184, s68, -v49
    v_fma_f32 v185, v185, s68, -v49
    v_fma_f32 v186, v186, s68, -v49
    v_fma_f32 v187, v187, s68, -v49
    v_fma_f32 v188, v188, s68, -v49
    v_fma_f32 v189, v189, s68, -v49
    v_fma_f32 v190, v190, s68, -v49
    v_fma_f32 v191, v191, s68, -v49
    v_exp_f32 v184, v184
    v_exp_f32 v185, v185
    v_exp_f32 v186, v186
    v_exp_f32 v187, v187
    v_exp_f32 v188, v188
    v_exp_f32 v189, v189
    v_exp_f32 v190, v190
    v_exp_f32 v191, v191
    v_add_f32 v36, v36, v184
    v_add_f32 v37, v37, v185
    v_add_f32 v38, v38, v186
    v_add_f32 v39, v39, v187
    v_add_f32 v36, v36, v188
    v_add_f32 v37, v37, v189
    v_add_f32 v38, v38, v190
    v_add_f32 v39, v39, v191
    v_cvt_pk_bf16_f32 v180, v184, v185
    v_cvt_pk_bf16_f32 v181, v186, v187
    v_cvt_pk_bf16_f32 v182, v188, v189
    v_cvt_pk_bf16_f32 v183, v190, v191
    ds_write_b128 v16, v[180:183] offset:19456
    v_add_f32 v32, v32, v33
    v_add_f32 v34, v34, v35
    v_add_f32 v36, v36, v37
    v_add_f32 v38, v38, v39
    v_add_f32 v50, v32, v34
    v_add_f32 v51, v36, v38
    v_mov_b32 v52, v50
    v_mov_b32 v53, v51
    s_nop 0
    v_permlane32_swap_b32 v50, v52
    v_permlane32_swap_b32 v51, v53
    v_add_f32 v50, v50, v52
    v_add_f32 v51, v51, v53
    ds_write_b32 v22, v50 offset:0
    ds_write_b32 v22, v51 offset:128
    s_waitcnt lgkmcnt(0)
    s_barrier
    ds_read_b64_tr_b16 v[64:65], v15 offset:0
    ds_read_b64_tr_b16 v[66:67], v15 offset:512
    ds_read_b64_tr_b16 v[68:69], v15 offset:64
    ds_read_b64_tr_b16 v[70:71], v15 offset:576
    ds_read_b64_tr_b16 v[72:73], v15 offset:128
    ds_read_b64_tr_b16 v[74:75], v15 offset:640
    ds_read_b64_tr_b16 v[76:77], v15 offset:192
    ds_read_b64_tr_b16 v[78:79], v15 offset:704
    s_waitcnt lgkmcnt(6)
    s_add_u32 s59, s66, 0
    buffer_store_dwordx4 v[64:67], v5, s[36:39], s59 offen sc1
    s_waitcnt lgkmcnt(4)
    s_add_u32 s60, s66, 262144
    buffer_store_dwordx4 v[68:71], v5, s[36:39], s60 offen sc1
    s_waitcnt lgkmcnt(2)
    s_add_u32 s61, s66, 524288
    buffer_store_dwordx4 v[72:75], v5, s[36:39], s61 offen sc1
    s_waitcnt lgkmcnt(0)
    s_add_u32 s62, s66, 786432
    buffer_store_dwordx4 v[76:79], v5, s[36:39], s62 offen sc1
K1_END:
    s_endpgm
K1_LOADER:
    v_lshrrev_b32 v10, 3, v1
    v_lshlrev_b32 v10, 13, v10
    v_and_b32 v11, 7, v1
    v_lshl_add_u32 v2, v11, 4, v10
    v_lshrrev_b32 v12, 4, v1
    v_and_b32 v13, 15, v1
    v_lshlrev_b32 v10, 15, v12
    v_lshl_add_u32 v3, v13, 4, v10
    v_lshlrev_b32 v10, 12, v12
    v_lshl_add_u32 v6, v13, 4, v10
    v_and_b32 v10, 1, v12
    v_lshlrev_b32 v10, 3, v10
    v_xor_b32 v10, v10, v13
    v_lshlrev_b32 v11, 8, v12
    v_lshl_add_u32 v4, v10, 4, v11
    v_lshlrev_b32 v5, 4, v1
    v_lshlrev_b32 v8, 7, v1
    s_lshl_b32 s44, s41, 16
    s_lshl_b32 s45, s42, 8
    s_sub_u32 s58, s40, 1
    s_and_b32 s58, s58, 1
    s_lshl_b32 s56, s58, 18
    s_add_u32 s45, s45, s56
    s_mul_i32 s47, s58, 8704
    s_add_u32 s48, s47, 8320
    s_lshl_b32 s46, s41, 3
    s_add_u32 s46, s46, s43
    s_lshl_b32 s46, s46, 17
    s_lshl_b32 s57, s40, 15
    s_add_u32 s56, s71, 0
    s_and_b32 s56, s56, 3
    s_lshl_b32 s56, s56, 13
    s_add_u32 s72, s46, s56
    s_add_u32 s76, s72, s57
    s_add_u32 s56, s71, 1
    s_and_b32 s56, s56, 3
    s_lshl_b32 s56, s56, 13
    s_add_u32 s73, s46, s56
    s_add_u32 s77, s73, s57
    s_add_u32 s56, s71, 2
    s_and_b32 s56, s56, 3
    s_lshl_b32 s56, s56, 13
    s_add_u32 s74, s46, s56
    s_add_u32 s78, s74, s57
    s_add_u32 s56, s71, 3
    s_and_b32 s56, s56, 3
    s_lshl_b32 s56, s56, 13
    s_add_u32 s75, s46, s56
    s_add_u32 s79, s75, s57
    s_waitcnt lgkmcnt(0)
    s_mov_b32 s16, s4
    s_and_b32 s17, s5, 0xffff
    s_mov_b32 s18, 524288
    s_mov_b32 s19, 0x00020000
    s_mov_b32 s28, s10
    s_and_b32 s29, s11, 0xffff
    s_mov_b32 s30, 4194304
    s_mov_b32 s31, 0x00020000
    s_mov_b32 s20, s6
    s_and_b32 s21, s7, 0xffff
    s_mov_b32 s22, 8388608
    s_mov_b32 s23, 0x00020000
    s_mov_b32 s24, s8
    s_and_b32 s25, s9, 0xffff
    s_mov_b32 s26, 8388608
    s_mov_b32 s27, 0x00020000
    s_mov_b32 s32, s12
    s_and_b32 s33, s13, 0xffff
    s_mov_b32 s34, 4194304
    s_mov_b32 s35, 0x00020000
    s_mov_b32 s36, s14
    s_and_b32 s37, s15, 0xffff
    s_mov_b32 s38, 8388608
    s_mov_b32 s39, 0x00020000
    s_cmp_eq_u32 s40, 3
    s_cbranch_scc1 K1_AUX
    s_add_u32 s70, s69, 0
    s_and_b32 s70, s70, 7
    s_cmp_eq_u32 s40, 0
    s_cbranch_scc1 K1_ST1_X
    s_lshl_b32 s57, s70, 19
    s_add_u32 s57, s57, s45
    s_add_u32 m0, s48, 0
    s_add_u32 s58, s57, 0
    buffer_load_dwordx4 v3, s[28:31], s58 offen lds
    s_add_u32 m0, s48, 1088
    s_add_u32 s59, s57, 8192
    buffer_load_dwordx4 v3, s[28:31], s59 offen lds
    s_add_u32 m0, s48, 2176
    s_add_u32 s60, s57, 16384
    buffer_load_dwordx4 v3, s[28:31], s60 offen lds
    s_add_u32 m0, s48, 3264
    s_add_u32 s61, s57, 24576
    buffer_load_dwordx4 v3, s[28:31], s61 offen lds
    s_add_u32 m0, s48, 4352
    s_add_u32 s62, s57, 131072
    buffer_load_dwordx4 v3, s[28:31], s62 offen lds
    s_add_u32 m0, s48, 5440
    s_add_u32 s63, s57, 139264
    buffer_load_dwordx4 v3, s[28:31], s63 offen lds
    s_add_u32 m0, s48, 6528
    s_add_u32 s56, s57, 147456
    buffer_load_dwordx4 v3, s[28:31], s56 offen lds
    s_add_u32 m0, s48, 7616
    s_add_u32 s57, s57, 155648
    buffer_load_dwordx4 v3, s[28:31], s57 offen lds
    s_branch K1_ST1_E
K1_ST1_X:
    s_lshl_b32 s58, s70, 7
    s_add_u32 s58, s58, s44
    s_mov_b32 m0, 0
    s_add_u32 s59, s58, 0
    buffer_load_dwordx4 v2, s[16:19], s59 offen lds
    s_mov_b32 m0, 1040
    s_add_u32 s60, s58, 1024
    buffer_load_dwordx4 v2, s[16:19], s60 offen lds
    s_mov_b32 m0, 2080
    s_add_u32 s61, s58, 2048
    buffer_load_dwordx4 v2, s[16:19], s61 offen lds
    s_mov_b32 m0, 3120
    s_add_u32 s62, s58, 3072
    buffer_load_dwordx4 v2, s[16:19], s62 offen lds
    s_mov_b32 m0, 4160
    s_add_u32 s63, s58, 4096
    buffer_load_dwordx4 v2, s[16:19], s63 offen lds
    s_mov_b32 m0, 5200
    s_add_u32 s56, s58, 5120
    buffer_load_dwordx4 v2, s[16:19], s56 offen lds
    s_mov_b32 m0, 6240
    s_add_u32 s57, s58, 6144
    buffer_load_dwordx4 v2, s[16:19], s57 offen lds
    s_mov_b32 m0, 7280
    s_add_u32 s58, s58, 7168
    buffer_load_dwordx4 v2, s[16:19], s58 offen lds
K1_ST1_E:
    s_add_u32 s70, s69, 1
    s_and_b32 s70, s70, 7
    s_cmp_eq_u32 s40, 0
    s_cbranch_scc1 K1_ST2_X
    s_lshl_b32 s59, s70, 19
    s_add_u32 s59, s59, s45
    s_add_u32 m0, s48, 25728
    s_add_u32 s60, s59, 0
    buffer_load_dwordx4 v3, s[28:31], s60 offen lds
    s_add_u32 m0, s48, 26816
    s_add_u32 s61, s59, 8192
    buffer_load_dwordx4 v3, s[28:31], s61 offen lds
    s_add_u32 m0, s48, 27904
    s_add_u32 s62, s59, 16384
    buffer_load_dwordx4 v3, s[28:31], s62 offen lds
    s_add_u32 m0, s48, 28992
    s_add_u32 s63, s59, 24576
    buffer_load_dwordx4 v3, s[28:31], s63 offen lds
    s_add_u32 m0, s48, 30080
    s_add_u32 s56, s59, 131072
    buffer_load_dwordx4 v3, s[28:31], s56 offen lds
    s_add_u32 m0, s48, 31168
    s_add_u32 s57, s59, 139264
    buffer_load_dwordx4 v3, s[28:31], s57 offen lds
    s_add_u32 m0, s48, 32256
    s_add_u32 s58, s59, 147456
    buffer_load_dwordx4 v3, s[28:31], s58 offen lds
    s_add_u32 m0, s48, 33344
    s_add_u32 s59, s59, 155648
    buffer_load_dwordx4 v3, s[28:31], s59 offen lds
    s_branch K1_ST2_E
K1_ST2_X:
    s_lshl_b32 s60, s70, 7
    s_add_u32 s60, s60, s44
    s_mov_b32 m0, 25728
    s_add_u32 s61, s60, 0
    buffer_load_dwordx4 v2, s[16:19], s61 offen lds
    s_mov_b32 m0, 26768
    s_add_u32 s62, s60, 1024
    buffer_load_dwordx4 v2, s[16:19], s62 offen lds
    s_mov_b32 m0, 27808
    s_add_u32 s63, s60, 2048
    buffer_load_dwordx4 v2, s[16:19], s63 offen lds
    s_mov_b32 m0, 28848
    s_add_u32 s56, s60, 3072
    buffer_load_dwordx4 v2, s[16:19], s56 offen lds
    s_mov_b32 m0, 29888
    s_add_u32 s57, s60, 4096
    buffer_load_dwordx4 v2, s[16:19], s57 offen lds
    s_mov_b32 m0, 30928
    s_add_u32 s58, s60, 5120
    buffer_load_dwordx4 v2, s[16:19], s58 offen lds
    s_mov_b32 m0, 31968
    s_add_u32 s59, s60, 6144
    buffer_load_dwordx4 v2, s[16:19], s59 offen lds
    s_mov_b32 m0, 33008
    s_add_u32 s60, s60, 7168
    buffer_load_dwordx4 v2, s[16:19], s60 offen lds
K1_ST2_E:
    v_lshrrev_b32 v14, 5, v1
    v_and_b32 v15, 1, v12
    v_lshrrev_b32 v16, 2, v1
    v_and_b32 v16, 3, v16
    v_and_b32 v17, 3, v1
    v_lshl_add_u32 v10, v14, 2, v16
    v_mul_u32_u24 v10, 1088, v10
    v_lshl_add_u32 v10, v15, 5, v10
    v_lshl_add_u32 v10, v17, 3, v10
    s_lshl_b32 s56, s40, 6
    v_add_u32 v21, s56, v10
    v_add_u32 v22, 69632, v21
    v_add_u32 v23, 139264, v21
    v_add_u32 v24, 34816, v5
    v_and_b32 v10, 31, v1
    v_lshlrev_b32 v10, 2, v10
    v_add_u32 v25, 69632, v10
    s_lshl_b32 s64, s2, 14
    s_lshl_b32 s56, s40, 8
    s_add_u32 s64, s64, s56
    s_mul_i32 s65, s40, 4352
    s_add_u32 s65, s65, 112000
    s_lshl_b32 s67, s41, 9
    s_lshl_b32 s56, s42, 3
    s_add_u32 s67, s67, s56
    s_lshl_b32 s56, s40, 1
    s_add_u32 s67, s67, s56
    s_lshl_b32 s67, s67, 10
    s_waitcnt vmcnt(8)
    s_barrier
    s_add_u32 s70, s69, 2
    s_and_b32 s70, s70, 7
    s_cmp_eq_u32 s40, 0
    s_cbranch_scc1 K1_ST3_X
    s_lshl_b32 s61, s70, 19
    s_add_u32 s61, s61, s45
    s_add_u32 m0, s48, 51456
    s_add_u32 s62, s61, 0
    buffer_load_dwordx4 v3, s[28:31], s62 offen lds
    s_add_u32 m0, s48, 52544
    s_add_u32 s63, s61, 8192
    buffer_load_dwordx4 v3, s[28:31], s63 offen lds
    s_add_u32 m0, s48, 53632
    s_add_u32 s56, s61, 16384
    buffer_load_dwordx4 v3, s[28:31], s56 offen lds
    s_add_u32 m0, s48, 54720
    s_add_u32 s57, s61, 24576
    buffer_load_dwordx4 v3, s[28:31], s57 offen lds
    s_add_u32 m0, s48, 55808
    s_add_u32 s58, s61, 131072
    buffer_load_dwordx4 v3, s[28:31], s58 offen lds
    s_add_u32 m0, s48, 56896
    s_add_u32 s59, s61, 139264
    buffer_load_dwordx4 v3, s[28:31], s59 offen lds
    s_add_u32 m0, s48, 57984
    s_add_u32 s60, s61, 147456
    buffer_load_dwordx4 v3, s[28:31], s60 offen lds
    s_add_u32 m0, s48, 59072
    s_add_u32 s61, s61, 155648
    buffer_load_dwordx4 v3, s[28:31], s61 offen lds
    s_branch K1_ST3_E
K1_ST3_X:
    s_lshl_b32 s62, s70, 7
    s_add_u32 s62, s62, s44
    s_mov_b32 m0, 51456
    s_add_u32 s63, s62, 0
    buffer_load_dwordx4 v2, s[16:19], s63 offen lds
    s_mov_b32 m0, 52496
    s_add_u32 s56, s62, 1024
    buffer_load_dwordx4 v2, s[16:19], s56 offen lds
    s_mov_b32 m0, 53536
    s_add_u32 s57, s62, 2048
    buffer_load_dwordx4 v2, s[16:19], s57 offen lds
    s_mov_b32 m0, 54576
    s_add_u32 s58, s62, 3072
    buffer_load_dwordx4 v2, s[16:19], s58 offen lds
    s_mov_b32 m0, 55616
    s_add_u32 s59, s62, 4096
    buffer_load_dwordx4 v2, s[16:19], s59 offen lds
    s_mov_b32 m0, 56656
    s_add_u32 s60, s62, 5120
    buffer_load_dwordx4 v2, s[16:19], s60 offen lds
    s_mov_b32 m0, 57696
    s_add_u32 s61, s62, 6144
    buffer_load_dwordx4 v2, s[16:19], s61 offen lds
    s_mov_b32 m0, 58736
    s_add_u32 s62, s62, 7168
    buffer_load_dwordx4 v2, s[16:19], s62 offen lds
K1_ST3_E:
    s_waitcnt vmcnt(8)
    s_barrier
    s_add_u32 s70, s69, 3
    s_and_b32 s70, s70, 7
    s_cmp_eq_u32 s40, 0
    s_cbranch_scc1 K1_ST4_X
    s_lshl_b32 s63, s70, 19
    s_add_u32 s63, s63, s45
    s_add_u32 m0, s48, 0
    s_add_u32 s56, s63, 0
    buffer_load_dwordx4 v3, s[28:31], s56 offen lds
    s_add_u32 m0, s48, 1088
    s_add_u32 s57, s63, 8192
    buffer_load_dwordx4 v3, s[28:31], s57 offen lds
    s_add_u32 m0, s48, 2176
    s_add_u32 s58, s63, 16384
    buffer_load_dwordx4 v3, s[28:31], s58 offen lds
    s_add_u32 m0, s48, 3264
    s_add_u32 s59, s63, 24576
    buffer_load_dwordx4 v3, s[28:31], s59 offen lds
    s_add_u32 m0, s48, 4352
    s_add_u32 s60, s63, 131072
    buffer_load_dwordx4 v3, s[28:31], s60 offen lds
    s_add_u32 m0, s48, 5440
    s_add_u32 s61, s63, 139264
    buffer_load_dwordx4 v3, s[28:31], s61 offen lds
    s_add_u32 m0, s48, 6528
    s_add_u32 s62, s63, 147456
    buffer_load_dwordx4 v3, s[28:31], s62 offen lds
    s_add_u32 m0, s48, 7616
    s_add_u32 s63, s63, 155648
    buffer_load_dwordx4 v3, s[28:31], s63 offen lds
    s_branch K1_ST4_E
K1_ST4_X:
    s_lshl_b32 s56, s70, 7
    s_add_u32 s56, s56, s44
    s_mov_b32 m0, 0
    s_add_u32 s57, s56, 0
    buffer_load_dwordx4 v2, s[16:19], s57 offen lds
    s_mov_b32 m0, 1040
    s_add_u32 s58, s56, 1024
    buffer_load_dwordx4 v2, s[16:19], s58 offen lds
    s_mov_b32 m0, 2080
    s_add_u32 s59, s56, 2048
    buffer_load_dwordx4 v2, s[16:19], s59 offen lds
    s_mov_b32 m0, 3120
    s_add_u32 s60, s56, 3072
    buffer_load_dwordx4 v2, s[16:19], s60 offen lds
    s_mov_b32 m0, 4160
    s_add_u32 s61, s56, 4096
    buffer_load_dwordx4 v2, s[16:19], s61 offen lds
    s_mov_b32 m0, 5200
    s_add_u32 s62, s56, 5120
    buffer_load_dwordx4 v2, s[16:19], s62 offen lds
    s_mov_b32 m0, 6240
    s_add_u32 s63, s56, 6144
    buffer_load_dwordx4 v2, s[16:19], s63 offen lds
    s_mov_b32 m0, 7280
    s_add_u32 s56, s56, 7168
    buffer_load_dwordx4 v2, s[16:19], s56 offen lds
K1_ST4_E:
    s_waitcnt vmcnt(8)
    s_barrier
    s_add_u32 s70, s69, 4
    s_and_b32 s70, s70, 7
    s_cmp_eq_u32 s40, 0
    s_cbranch_scc1 K1_ST5_X
    s_lshl_b32 s57, s70, 19
    s_add_u32 s57, s57, s45
    s_add_u32 m0, s48, 25728
    s_add_u32 s58, s57, 0
    buffer_load_dwordx4 v3, s[28:31], s58 offen lds
    s_add_u32 m0, s48, 26816
    s_add_u32 s59, s57, 8192
    buffer_load_dwordx4 v3, s[28:31], s59 offen lds
    s_add_u32 m0, s48, 27904
    s_add_u32 s60, s57, 16384
    buffer_load_dwordx4 v3, s[28:31], s60 offen lds
    s_add_u32 m0, s48, 28992
    s_add_u32 s61, s57, 24576
    buffer_load_dwordx4 v3, s[28:31], s61 offen lds
    s_add_u32 m0, s48, 30080
    s_add_u32 s62, s57, 131072
    buffer_load_dwordx4 v3, s[28:31], s62 offen lds
    s_add_u32 m0, s48, 31168
    s_add_u32 s63, s57, 139264
    buffer_load_dwordx4 v3, s[28:31], s63 offen lds
    s_add_u32 m0, s48, 32256
    s_add_u32 s56, s57, 147456
    buffer_load_dwordx4 v3, s[28:31], s56 offen lds
    s_add_u32 m0, s48, 33344
    s_add_u32 s57, s57, 155648
    buffer_load_dwordx4 v3, s[28:31], s57 offen lds
    s_branch K1_ST5_E
K1_ST5_X:
    s_lshl_b32 s58, s70, 7
    s_add_u32 s58, s58, s44
    s_mov_b32 m0, 25728
    s_add_u32 s59, s58, 0
    buffer_load_dwordx4 v2, s[16:19], s59 offen lds
    s_mov_b32 m0, 26768
    s_add_u32 s60, s58, 1024
    buffer_load_dwordx4 v2, s[16:19], s60 offen lds
    s_mov_b32 m0, 27808
    s_add_u32 s61, s58, 2048
    buffer_load_dwordx4 v2, s[16:19], s61 offen lds
    s_mov_b32 m0, 28848
    s_add_u32 s62, s58, 3072
    buffer_load_dwordx4 v2, s[16:19], s62 offen lds
    s_mov_b32 m0, 29888
    s_add_u32 s63, s58, 4096
    buffer_load_dwordx4 v2, s[16:19], s63 offen lds
    s_mov_b32 m0, 30928
    s_add_u32 s56, s58, 5120
    buffer_load_dwordx4 v2, s[16:19], s56 offen lds
    s_mov_b32 m0, 31968
    s_add_u32 s57, s58, 6144
    buffer_load_dwordx4 v2, s[16:19], s57 offen lds
    s_mov_b32 m0, 33008
    s_add_u32 s58, s58, 7168
    buffer_load_dwordx4 v2, s[16:19], s58 offen lds
K1_ST5_E:
    s_waitcnt vmcnt(8)
    s_barrier
    s_add_u32 s70, s69, 5
    s_and_b32 s70, s70, 7
    s_cmp_eq_u32 s40, 0
    s_cbranch_scc1 K1_ST6_X
    s_lshl_b32 s59, s70, 19
    s_add_u32 s59, s59, s45
    s_add_u32 m0, s48, 51456
    s_add_u32 s60, s59, 0
    buffer_load_dwordx4 v3, s[28:31], s60 offen lds
    s_add_u32 m0, s48, 52544
    s_add_u32 s61, s59, 8192
    buffer_load_dwordx4 v3, s[28:31], s61 offen lds
    s_add_u32 m0, s48, 53632
    s_add_u32 s62, s59, 16384
    buffer_load_dwordx4 v3, s[28:31], s62 offen lds
    s_add_u32 m0, s48, 54720
    s_add_u32 s63, s59, 24576
    buffer_load_dwordx4 v3, s[28:31], s63 offen lds
    s_add_u32 m0, s48, 55808
    s_add_u32 s56, s59, 131072
    buffer_load_dwordx4 v3, s[28:31], s56 offen lds
    s_add_u32 m0, s48, 56896
    s_add_u32 s57, s59, 139264
    buffer_load_dwordx4 v3, s[28:31], s57 offen lds
    s_add_u32 m0, s48, 57984
    s_add_u32 s58, s59, 147456
    buffer_load_dwordx4 v3, s[28:31], s58 offen lds
    s_add_u32 m0, s48, 59072
    s_add_u32 s59, s59, 155648
    buffer_load_dwordx4 v3, s[28:31], s59 offen lds
    s_branch K1_ST6_E
K1_ST6_X:
    s_lshl_b32 s60, s70, 7
    s_add_u32 s60, s60, s44
    s_mov_b32 m0, 51456
    s_add_u32 s61, s60, 0
    buffer_load_dwordx4 v2, s[16:19], s61 offen lds
    s_mov_b32 m0, 52496
    s_add_u32 s62, s60, 1024
    buffer_load_dwordx4 v2, s[16:19], s62 offen lds
    s_mov_b32 m0, 53536
    s_add_u32 s63, s60, 2048
    buffer_load_dwordx4 v2, s[16:19], s63 offen lds
    s_mov_b32 m0, 54576
    s_add_u32 s56, s60, 3072
    buffer_load_dwordx4 v2, s[16:19], s56 offen lds
    s_mov_b32 m0, 55616
    s_add_u32 s57, s60, 4096
    buffer_load_dwordx4 v2, s[16:19], s57 offen lds
    s_mov_b32 m0, 56656
    s_add_u32 s58, s60, 5120
    buffer_load_dwordx4 v2, s[16:19], s58 offen lds
    s_mov_b32 m0, 57696
    s_add_u32 s59, s60, 6144
    buffer_load_dwordx4 v2, s[16:19], s59 offen lds
    s_mov_b32 m0, 58736
    s_add_u32 s60, s60, 7168
    buffer_load_dwordx4 v2, s[16:19], s60 offen lds
K1_ST6_E:
    s_waitcnt vmcnt(8)
    s_barrier
    s_add_u32 s70, s69, 6
    s_and_b32 s70, s70, 7
    s_cmp_eq_u32 s40, 0
    s_cbranch_scc1 K1_ST7_X
    s_lshl_b32 s61, s70, 19
    s_add_u32 s61, s61, s45
    s_add_u32 m0, s48, 0
    s_add_u32 s62, s61, 0
    buffer_load_dwordx4 v3, s[28:31], s62 offen lds
    s_add_u32 m0, s48, 1088
    s_add_u32 s63, s61, 8192
    buffer_load_dwordx4 v3, s[28:31], s63 offen lds
    s_add_u32 m0, s48, 2176
    s_add_u32 s56, s61, 16384
    buffer_load_dwordx4 v3, s[28:31], s56 offen lds
    s_add_u32 m0, s48, 3264
    s_add_u32 s57, s61, 24576
    buffer_load_dwordx4 v3, s[28:31], s57 offen lds
    s_add_u32 m0, s48, 4352
    s_add_u32 s58, s61, 131072
    buffer_load_dwordx4 v3, s[28:31], s58 offen lds
    s_add_u32 m0, s48, 5440
    s_add_u32 s59, s61, 139264
    buffer_load_dwordx4 v3, s[28:31], s59 offen lds
    s_add_u32 m0, s48, 6528
    s_add_u32 s60, s61, 147456
    buffer_load_dwordx4 v3, s[28:31], s60 offen lds
    s_add_u32 m0, s48, 7616
    s_add_u32 s61, s61, 155648
    buffer_load_dwordx4 v3, s[28:31], s61 offen lds
    s_branch K1_ST7_E
K1_ST7_X:
    s_lshl_b32 s62, s70, 7
    s_add_u32 s62, s62, s44
    s_mov_b32 m0, 0
    s_add_u32 s63, s62, 0
    buffer_load_dwordx4 v2, s[16:19], s63 offen lds
    s_mov_b32 m0, 1040
    s_add_u32 s56, s62, 1024
    buffer_load_dwordx4 v2, s[16:19], s56 offen lds
    s_mov_b32 m0, 2080
    s_add_u32 s57, s62, 2048
    buffer_load_dwordx4 v2, s[16:19], s57 offen lds
    s_mov_b32 m0, 3120
    s_add_u32 s58, s62, 3072
    buffer_load_dwordx4 v2, s[16:19], s58 offen lds
    s_mov_b32 m0, 4160
    s_add_u32 s59, s62, 4096
    buffer_load_dwordx4 v2, s[16:19], s59 offen lds
    s_mov_b32 m0, 5200
    s_add_u32 s60, s62, 5120
    buffer_load_dwordx4 v2, s[16:19], s60 offen lds
    s_mov_b32 m0, 6240
    s_add_u32 s61, s62, 6144
    buffer_load_dwordx4 v2, s[16:19], s61 offen lds
    s_mov_b32 m0, 7280
    s_add_u32 s62, s62, 7168
    buffer_load_dwordx4 v2, s[16:19], s62 offen lds
K1_ST7_E:
    s_waitcnt vmcnt(8)
    s_barrier
    s_add_u32 s70, s69, 7
    s_and_b32 s70, s70, 7
    s_cmp_eq_u32 s40, 0
    s_cbranch_scc1 K1_ST8_X
    s_lshl_b32 s63, s70, 19
    s_add_u32 s63, s63, s45
    s_add_u32 m0, s48, 25728
    s_add_u32 s56, s63, 0
    buffer_load_dwordx4 v3, s[28:31], s56 offen lds
    s_add_u32 m0, s48, 26816
    s_add_u32 s57, s63, 8192
    buffer_load_dwordx4 v3, s[28:31], s57 offen lds
    s_add_u32 m0, s48, 27904
    s_add_u32 s58, s63, 16384
    buffer_load_dwordx4 v3, s[28:31], s58 offen lds
    s_add_u32 m0, s48, 28992
    s_add_u32 s59, s63, 24576
    buffer_load_dwordx4 v3, s[28:31], s59 offen lds
    s_add_u32 m0, s48, 30080
    s_add_u32 s60, s63, 131072
    buffer_load_dwordx4 v3, s[28:31], s60 offen lds
    s_add_u32 m0, s48, 31168
    s_add_u32 s61, s63, 139264
    buffer_load_dwordx4 v3, s[28:31], s61 offen lds
    s_add_u32 m0, s48, 32256
    s_add_u32 s62, s63, 147456
    buffer_load_dwordx4 v3, s[28:31], s62 offen lds
    s_add_u32 m0, s48, 33344
    s_add_u32 s63, s63, 155648
    buffer_load_dwordx4 v3, s[28:31], s63 offen lds
    s_branch K1_ST8_E
K1_ST8_X:
    s_lshl_b32 s56, s70, 7
    s_add_u32 s56, s56, s44
    s_mov_b32 m0, 25728
    s_add_u32 s57, s56, 0
    buffer_load_dwordx4 v2, s[16:19], s57 offen lds
    s_mov_b32 m0, 26768
    s_add_u32 s58, s56, 1024
    buffer_load_dwordx4 v2, s[16:19], s58 offen lds
    s_mov_b32 m0, 27808
    s_add_u32 s59, s56, 2048
    buffer_load_dwordx4 v2, s[16:19], s59 offen lds
    s_mov_b32 m0, 28848
    s_add_u32 s60, s56, 3072
    buffer_load_dwordx4 v2, s[16:19], s60 offen lds
    s_mov_b32 m0, 29888
    s_add_u32 s61, s56, 4096
    buffer_load_dwordx4 v2, s[16:19], s61 offen lds
    s_mov_b32 m0, 30928
    s_add_u32 s62, s56, 5120
    buffer_load_dwordx4 v2, s[16:19], s62 offen lds
    s_mov_b32 m0, 31968
    s_add_u32 s63, s56, 6144
    buffer_load_dwordx4 v2, s[16:19], s63 offen lds
    s_mov_b32 m0, 33008
    s_add_u32 s56, s56, 7168
    buffer_load_dwordx4 v2, s[16:19], s56 offen lds
K1_ST8_E:
    s_waitcnt vmcnt(8)
    s_barrier
    s_waitcnt vmcnt(0)
    s_barrier
    s_barrier
    s_branch K1_LTAIL
K1_AUX:
    v_lshrrev_b32 v14, 5, v1
    v_and_b32 v15, 1, v12
    v_lshrrev_b32 v16, 2, v1
    v_and_b32 v16, 3, v16
    v_and_b32 v17, 3, v1
    v_lshl_add_u32 v10, v14, 2, v16
    v_mul_u32_u24 v10, 1088, v10
    v_lshl_add_u32 v10, v15, 5, v10
    v_lshl_add_u32 v10, v17, 3, v10
    s_lshl_b32 s56, s40, 6
    v_add_u32 v21, s56, v10
    v_add_u32 v22, 69632, v21
    v_add_u32 v23, 139264, v21
    v_add_u32 v24, 34816, v5
    v_and_b32 v10, 31, v1
    v_lshlrev_b32 v10, 2, v10
    v_add_u32 v25, 69632, v10
    s_lshl_b32 s64, s2, 14
    s_lshl_b32 s56, s40, 8
    s_add_u32 s64, s64, s56
    s_mul_i32 s65, s40, 4352
    s_add_u32 s65, s65, 112000
    s_lshl_b32 s67, s41, 9
    s_lshl_b32 s56, s42, 3
    s_add_u32 s67, s67, s56
    s_lshl_b32 s56, s40, 1
    s_add_u32 s67, s67, s56
    s_lshl_b32 s67, s67, 10
    s_barrier
    s_barrier
    s_mov_b32 m0, 77184
    s_add_u32 s57, s72, 0
    buffer_load_dwordx4 v4, s[20:23], s57 offen lds
    s_mov_b32 m0, 78224
    s_add_u32 s58, s72, 1024
    buffer_load_dwordx4 v4, s[20:23], s58 offen lds
    s_mov_b32 m0, 79264
    s_add_u32 s59, s72, 2048
    buffer_load_dwordx4 v4, s[20:23], s59 offen lds
    s_mov_b32 m0, 80304
    s_add_u32 s60, s72, 3072
    buffer_load_dwordx4 v4, s[20:23], s60 offen lds
    s_mov_b32 m0, 81344
    s_add_u32 s61, s72, 4096
    buffer_load_dwordx4 v4, s[20:23], s61 offen lds
    s_mov_b32 m0, 82384
    s_add_u32 s62, s72, 5120
    buffer_load_dwordx4 v4, s[20:23], s62 offen lds
    s_mov_b32 m0, 83424
    s_add_u32 s63, s72, 6144
    buffer_load_dwordx4 v4, s[20:23], s63 offen lds
    s_mov_b32 m0, 84464
    s_add_u32 s56, s72, 7168
    buffer_load_dwordx4 v4, s[20:23], s56 offen lds
    s_mov_b32 m0, 85888
    s_add_u32 s57, s72, 32768
    buffer_load_dwordx4 v4, s[20:23], s57 offen lds
    s_mov_b32 m0, 86928
    s_add_u32 s58, s72, 33792
    buffer_load_dwordx4 v4, s[20:23], s58 offen lds
    s_mov_b32 m0, 87968
    s_add_u32 s59, s72, 34816
    buffer_load_dwordx4 v4, s[20:23], s59 offen lds
    s_mov_b32 m0, 89008
    s_add_u32 s60, s72, 35840
    buffer_load_dwordx4 v4, s[20:23], s60 offen lds
    s_mov_b32 m0, 90048
    s_add_u32 s61, s72, 36864
    buffer_load_dwordx4 v4, s[20:23], s61 offen lds
    s_mov_b32 m0, 91088
    s_add_u32 s62, s72, 37888
    buffer_load_dwordx4 v4, s[20:23], s62 offen lds
    s_mov_b32 m0, 92128
    s_add_u32 s63, s72, 38912
    buffer_load_dwordx4 v4, s[20:23], s63 offen lds
    s_mov_b32 m0, 93168
    s_add_u32 s56, s72, 39936
    buffer_load_dwordx4 v4, s[20:23], s56 offen lds
    s_barrier
    s_mov_b32 m0, 94592
    s_add_u32 s57, s72, 65536
    buffer_load_dwordx4 v4, s[20:23], s57 offen lds
    s_mov_b32 m0, 95632
    s_add_u32 s58, s72, 66560
    buffer_load_dwordx4 v4, s[20:23], s58 offen lds
    s_mov_b32 m0, 96672
    s_add_u32 s59, s72, 67584
    buffer_load_dwordx4 v4, s[20:23], s59 offen lds
    s_mov_b32 m0, 97712
    s_add_u32 s60, s72, 68608
    buffer_load_dwordx4 v4, s[20:23], s60 offen lds
    s_mov_b32 m0, 98752
    s_add_u32 s61, s72, 69632
    buffer_load_dwordx4 v4, s[20:23], s61 offen lds
    s_mov_b32 m0, 99792
    s_add_u32 s62, s72, 70656
    buffer_load_dwordx4 v4, s[20:23], s62 offen lds
    s_mov_b32 m0, 100832
    s_add_u32 s63, s72, 71680
    buffer_load_dwordx4 v4, s[20:23], s63 offen lds
    s_mov_b32 m0, 101872
    s_add_u32 s56, s72, 72704
    buffer_load_dwordx4 v4, s[20:23], s56 offen lds
    s_mov_b32 m0, 103296
    s_add_u32 s57, s72, 98304
    buffer_load_dwordx4 v4, s[20:23], s57 offen lds
    s_mov_b32 m0, 104336
    s_add_u32 s58, s72, 99328
    buffer_load_dwordx4 v4, s[20:23], s58 offen lds
    s_mov_b32 m0, 105376
    s_add_u32 s59, s72, 100352
    buffer_load_dwordx4 v4, s[20:23], s59 offen lds
    s_mov_b32 m0, 106416
    s_add_u32 s60, s72, 101376
    buffer_load_dwordx4 v4, s[20:23], s60 offen lds
    s_mov_b32 m0, 107456
    s_add_u32 s61, s72, 102400
    buffer_load_dwordx4 v4, s[20:23], s61 offen lds
    s_mov_b32 m0, 108496
    s_add_u32 s62, s72, 103424
    buffer_load_dwordx4 v4, s[20:23], s62 offen lds
    s_mov_b32 m0, 109536
    s_add_u32 s63, s72, 104448
    buffer_load_dwordx4 v4, s[20:23], s63 offen lds
    s_mov_b32 m0, 110576
    s_add_u32 s56, s72, 105472
    buffer_load_dwordx4 v4, s[20:23], s56 offen lds
    s_barrier
    s_mov_b32 m0, 112000
    s_add_u32 s57, s73, 0
    buffer_load_dwordx4 v4, s[20:23], s57 offen lds
    s_mov_b32 m0, 113040
    s_add_u32 s58, s73, 1024
    buffer_load_dwordx4 v4, s[20:23], s58 offen lds
    s_mov_b32 m0, 114080
    s_add_u32 s59, s73, 2048
    buffer_load_dwordx4 v4, s[20:23], s59 offen lds
    s_mov_b32 m0, 115120
    s_add_u32 s60, s73, 3072
    buffer_load_dwordx4 v4, s[20:23], s60 offen lds
    s_mov_b32 m0, 116160
    s_add_u32 s61, s73, 4096
    buffer_load_dwordx4 v4, s[20:23], s61 offen lds
    s_mov_b32 m0, 117200
    s_add_u32 s62, s73, 5120
    buffer_load_dwordx4 v4, s[20:23], s62 offen lds
    s_mov_b32 m0, 118240
    s_add_u32 s63, s73, 6144
    buffer_load_dwordx4 v4, s[20:23], s63 offen lds
    s_mov_b32 m0, 119280
    s_add_u32 s56, s73, 7168
    buffer_load_dwordx4 v4, s[20:23], s56 offen lds
    s_mov_b32 m0, 120704
    s_add_u32 s57, s73, 32768
    buffer_load_dwordx4 v4, s[20:23], s57 offen lds
    s_mov_b32 m0, 121744
    s_add_u32 s58, s73, 33792
    buffer_load_dwordx4 v4, s[20:23], s58 offen lds
    s_mov_b32 m0, 122784
    s_add_u32 s59, s73, 34816
    buffer_load_dwordx4 v4, s[20:23], s59 offen lds
    s_mov_b32 m0, 123824
    s_add_u32 s60, s73, 35840
    buffer_load_dwordx4 v4, s[20:23], s60 offen lds
    s_mov_b32 m0, 124864
    s_add_u32 s61, s73, 36864
    buffer_load_dwordx4 v4, s[20:23], s61 offen lds
    s_mov_b32 m0, 125904
    s_add_u32 s62, s73, 37888
    buffer_load_dwordx4 v4, s[20:23], s62 offen lds
    s_mov_b32 m0, 126944
    s_add_u32 s63, s73, 38912
    buffer_load_dwordx4 v4, s[20:23], s63 offen lds
    s_mov_b32 m0, 127984
    s_add_u32 s56, s73, 39936
    buffer_load_dwordx4 v4, s[20:23], s56 offen lds
    s_barrier
    s_mov_b32 m0, 145792
    s_add_u32 s57, s73, 65536
    buffer_load_dwordx4 v4, s[20:23], s57 offen lds
    s_mov_b32 m0, 146832
    s_add_u32 s58, s73, 66560
    buffer_load_dwordx4 v4, s[20:23], s58 offen lds
    s_mov_b32 m0, 147872
    s_add_u32 s59, s73, 67584
    buffer_load_dwordx4 v4, s[20:23], s59 offen lds
    s_mov_b32 m0, 148912
    s_add_u32 s60, s73, 68608
    buffer_load_dwordx4 v4, s[20:23], s60 offen lds
    s_mov_b32 m0, 149952
    s_add_u32 s61, s73, 69632
    buffer_load_dwordx4 v4, s[20:23], s61 offen lds
    s_mov_b32 m0, 150992
    s_add_u32 s62, s73, 70656
    buffer_load_dwordx4 v4, s[20:23], s62 offen lds
    s_mov_b32 m0, 152032
    s_add_u32 s63, s73, 71680
    buffer_load_dwordx4 v4, s[20:23], s63 offen lds
    s_mov_b32 m0, 153072
    s_add_u32 s56, s73, 72704
    buffer_load_dwordx4 v4, s[20:23], s56 offen lds
    s_mov_b32 m0, 154496
    s_add_u32 s57, s73, 98304
    buffer_load_dwordx4 v4, s[20:23], s57 offen lds
    s_mov_b32 m0, 155536
    s_add_u32 s58, s73, 99328
    buffer_load_dwordx4 v4, s[20:23], s58 offen lds
    s_mov_b32 m0, 156576
    s_add_u32 s59, s73, 100352
    buffer_load_dwordx4 v4, s[20:23], s59 offen lds
    s_mov_b32 m0, 157616
    s_add_u32 s60, s73, 101376
    buffer_load_dwordx4 v4, s[20:23], s60 offen lds
    s_mov_b32 m0, 158656
    s_add_u32 s61, s73, 102400
    buffer_load_dwordx4 v4, s[20:23], s61 offen lds
    s_mov_b32 m0, 159696
    s_add_u32 s62, s73, 103424
    buffer_load_dwordx4 v4, s[20:23], s62 offen lds
    s_mov_b32 m0, 160736
    s_add_u32 s63, s73, 104448
    buffer_load_dwordx4 v4, s[20:23], s63 offen lds
    s_mov_b32 m0, 161776
    s_add_u32 s56, s73, 105472
    buffer_load_dwordx4 v4, s[20:23], s56 offen lds
    s_barrier
    s_barrier
    s_barrier
    s_waitcnt vmcnt(0)
    s_barrier
K1_LTAIL:
    s_add_u32 m0, s51, 0
    s_add_u32 s57, s78, 0
    buffer_load_dwordx4 v4, s[20:23], s57 offen lds
    s_add_u32 m0, s51, 1040
    s_add_u32 s58, s78, 1024
    buffer_load_dwordx4 v4, s[20:23], s58 offen lds
    s_add_u32 m0, s51, 2080
    s_add_u32 s59, s78, 2048
    buffer_load_dwordx4 v4, s[20:23], s59 offen lds
    s_add_u32 m0, s51, 3120
    s_add_u32 s60, s78, 3072
    buffer_load_dwordx4 v4, s[20:23], s60 offen lds
    s_add_u32 m0, s51, 4160
    s_add_u32 s61, s78, 4096
    buffer_load_dwordx4 v4, s[20:23], s61 offen lds
    s_add_u32 m0, s51, 5200
    s_add_u32 s62, s78, 5120
    buffer_load_dwordx4 v4, s[20:23], s62 offen lds
    s_add_u32 m0, s51, 6240
    s_add_u32 s63, s78, 6144
    buffer_load_dwordx4 v4, s[20:23], s63 offen lds
    s_add_u32 m0, s51, 7280
    s_add_u32 s56, s78, 7168
    buffer_load_dwordx4 v4, s[20:23], s56 offen lds
    s_add_u32 m0, s52, 0
    s_add_u32 s57, s79, 0
    buffer_load_dwordx4 v4, s[20:23], s57 offen lds
    s_add_u32 m0, s52, 1040
    s_add_u32 s58, s79, 1024
    buffer_load_dwordx4 v4, s[20:23], s58 offen lds
    s_add_u32 m0, s52, 2080
    s_add_u32 s59, s79, 2048
    buffer_load_dwordx4 v4, s[20:23], s59 offen lds
    s_add_u32 m0, s52, 3120
    s_add_u32 s60, s79, 3072
    buffer_load_dwordx4 v4, s[20:23], s60 offen lds
    s_add_u32 m0, s52, 4160
    s_add_u32 s61, s79, 4096
    buffer_load_dwordx4 v4, s[20:23], s61 offen lds
    s_add_u32 m0, s52, 5200
    s_add_u32 s62, s79, 5120
    buffer_load_dwordx4 v4, s[20:23], s62 offen lds
    s_add_u32 m0, s52, 6240
    s_add_u32 s63, s79, 6144
    buffer_load_dwordx4 v4, s[20:23], s63 offen lds
    s_add_u32 m0, s52, 7280
    s_add_u32 s56, s79, 7168
    buffer_load_dwordx4 v4, s[20:23], s56 offen lds
    s_waitcnt vmcnt(0)
    s_barrier
    s_add_u32 m0, s49, 0
    s_add_u32 s57, s76, 0
    buffer_load_dwordx4 v5, s[24:27], s57 offen lds
    s_add_u32 m0, s49, 1088
    s_add_u32 s58, s76, 1024
    buffer_load_dwordx4 v5, s[24:27], s58 offen lds
    s_add_u32 m0, s49, 2176
    s_add_u32 s59, s76, 2048
    buffer_load_dwordx4 v5, s[24:27], s59 offen lds
    s_add_u32 m0, s49, 3264
    s_add_u32 s60, s76, 3072
    buffer_load_dwordx4 v5, s[24:27], s60 offen lds
    s_add_u32 m0, s49, 4352
    s_add_u32 s61, s76, 4096
    buffer_load_dwordx4 v5, s[24:27], s61 offen lds
    s_add_u32 m0, s49, 5440
    s_add_u32 s62, s76, 5120
    buffer_load_dwordx4 v5, s[24:27], s62 offen lds
    s_add_u32 m0, s49, 6528
    s_add_u32 s63, s76, 6144
    buffer_load_dwordx4 v5, s[24:27], s63 offen lds
    s_add_u32 m0, s49, 7616
    s_add_u32 s56, s76, 7168
    buffer_load_dwordx4 v5, s[24:27], s56 offen lds
    s_add_u32 m0, s50, 0
    s_add_u32 s57, s77, 0
    buffer_load_dwordx4 v5, s[24:27], s57 offen lds
    s_add_u32 m0, s50, 1088
    s_add_u32 s58, s77, 1024
    buffer_load_dwordx4 v5, s[24:27], s58 offen lds
    s_add_u32 m0, s50, 2176
    s_add_u32 s59, s77, 2048
    buffer_load_dwordx4 v5, s[24:27], s59 offen lds
    s_add_u32 m0, s50, 3264
    s_add_u32 s60, s77, 3072
    buffer_load_dwordx4 v5, s[24:27], s60 offen lds
    s_add_u32 m0, s50, 4352
    s_add_u32 s61, s77, 4096
    buffer_load_dwordx4 v5, s[24:27], s61 offen lds
    s_add_u32 m0, s50, 5440
    s_add_u32 s62, s77, 5120
    buffer_load_dwordx4 v5, s[24:27], s62 offen lds
    s_add_u32 m0, s50, 6528
    s_add_u32 s63, s77, 6144
    buffer_load_dwordx4 v5, s[24:27], s63 offen lds
    s_add_u32 m0, s50, 7616
    s_add_u32 s56, s77, 7168
    buffer_load_dwordx4 v5, s[24:27], s56 offen lds
    s_barrier
    s_add_u32 m0, s51, 0
    s_add_u32 s57, s78, 0
    buffer_load_dwordx4 v5, s[24:27], s57 offen lds
    s_add_u32 m0, s51, 1088
    s_add_u32 s58, s78, 1024
    buffer_load_dwordx4 v5, s[24:27], s58 offen lds
    s_add_u32 m0, s51, 2176
    s_add_u32 s59, s78, 2048
    buffer_load_dwordx4 v5, s[24:27], s59 offen lds
    s_add_u32 m0, s51, 3264
    s_add_u32 s60, s78, 3072
    buffer_load_dwordx4 v5, s[24:27], s60 offen lds
    s_add_u32 m0, s51, 4352
    s_add_u32 s61, s78, 4096
    buffer_load_dwordx4 v5, s[24:27], s61 offen lds
    s_add_u32 m0, s51, 5440
    s_add_u32 s62, s78, 5120
    buffer_load_dwordx4 v5, s[24:27], s62 offen lds
    s_add_u32 m0, s51, 6528
    s_add_u32 s63, s78, 6144
    buffer_load_dwordx4 v5, s[24:27], s63 offen lds
    s_add_u32 m0, s51, 7616
    s_add_u32 s56, s78, 7168
    buffer_load_dwordx4 v5, s[24:27], s56 offen lds
    s_and_b32 s57, s40, 1
    s_lshl_b32 s57, s57, 13
    s_lshl_b32 s58, s2, 14
    s_add_u32 s57, s57, s58
    buffer_load_dword v20, v8, s[32:35], s57 offen
    s_waitcnt vmcnt(17)
    s_barrier
    ds_read_b64_tr_b16 v[32:33], v22 offset:7552
    ds_read_b64_tr_b16 v[34:35], v22 offset:7808
    ds_read_b128 v[96:99], v24 offset:0
    ds_read_b128 v[100:103], v24 offset:2048
    ds_read_b64_tr_b16 v[36:37], v22 offset:8064
    ds_read_b64_tr_b16 v[38:39], v22 offset:8320
    ds_read_b128 v[104:107], v24 offset:1024
    ds_read_b128 v[108:111], v24 offset:3072
    ds_read_b64_tr_b16 v[40:41], v22 offset:16256
    ds_read_b64_tr_b16 v[42:43], v22 offset:16512
    ds_read_b128 v[112:115], v24 offset:4096
    ds_read_b128 v[116:119], v24 offset:6144
    ds_read_b64_tr_b16 v[44:45], v22 offset:16768
    ds_read_b64_tr_b16 v[46:47], v22 offset:17024
    ds_read_b128 v[120:123], v24 offset:5120
    ds_read_b128 v[124:127], v24 offset:7168
    s_waitcnt lgkmcnt(12)
    v_mfma_f32_32x32x16_bf16 v[64:79], v[32:35], v[96:99], 0
    v_mfma_f32_32x32x16_bf16 v[80:95], v[32:35], v[100:103], 0
    ds_read_b64_tr_b16 v[32:33], v22 offset:24960
    ds_read_b64_tr_b16 v[34:35], v22 offset:25216
    ds_read_b128 v[96:99], v24 offset:8192
    ds_read_b128 v[100:103], v24 offset:10240
    s_waitcnt lgkmcnt(12)
    v_mfma_f32_32x32x16_bf16 v[64:79], v[36:39], v[104:107], v[64:79]
    v_mfma_f32_32x32x16_bf16 v[80:95], v[36:39], v[108:111], v[80:95]
    ds_read_b64_tr_b16 v[36:37], v22 offset:25472
    ds_read_b64_tr_b16 v[38:39], v22 offset:25728
    ds_read_b128 v[104:107], v24 offset:9216
    ds_read_b128 v[108:111], v24 offset:11264
    s_waitcnt lgkmcnt(12)
    v_mfma_f32_32x32x16_bf16 v[64:79], v[40:43], v[112:115], v[64:79]
    v_mfma_f32_32x32x16_bf16 v[80:95], v[40:43], v[116:119], v[80:95]
    ds_read_b64_tr_b16 v[40:41], v22 offset:33664
    ds_read_b64_tr_b16 v[42:43], v22 offset:33920
    ds_read_b128 v[112:115], v24 offset:12288
    ds_read_b128 v[116:119], v24 offset:14336
    s_waitcnt lgkmcnt(12)
    v_mfma_f32_32x32x16_bf16 v[64:79], v[44:47], v[120:123], v[64:79]
    v_mfma_f32_32x32x16_bf16 v[80:95], v[44:47], v[124:127], v[80:95]
    ds_read_b64_tr_b16 v[44:45], v22 offset:34176
    ds_read_b64_tr_b16 v[46:47], v22 offset:34432
    ds_read_b128 v[120:123], v24 offset:13312
    ds_read_b128 v[124:127], v24 offset:15360
    s_waitcnt lgkmcnt(12)
    v_mfma_f32_32x32x16_bf16 v[64:79], v[32:35], v[96:99], v[64:79]
    v_mfma_f32_32x32x16_bf16 v[80:95], v[32:35], v[100:103], v[80:95]
    s_waitcnt lgkmcnt(8)
    v_mfma_f32_32x32x16_bf16 v[64:79], v[36:39], v[104:107], v[64:79]
    v_mfma_f32_32x32x16_bf16 v[80:95], v[36:39], v[108:111], v[80:95]
    s_waitcnt lgkmcnt(4)
    v_mfma_f32_32x32x16_bf16 v[64:79], v[40:43], v[112:115], v[64:79]
    v_mfma_f32_32x32x16_bf16 v[80:95], v[40:43], v[116:119], v[80:95]
    s_waitcnt lgkmcnt(0)
    v_mfma_f32_32x32x16_bf16 v[64:79], v[44:47], v[120:123], v[64:79]
    v_mfma_f32_32x32x16_bf16 v[80:95], v[44:47], v[124:127], v[80:95]
    s_waitcnt vmcnt(9)
    s_barrier
    ds_read_b64_tr_b16 v[32:33], v22 offset:42368
    ds_read_b64_tr_b16 v[34:35], v22 offset:42624
    ds_read_b128 v[96:99], v24 offset:16384
    ds_read_b128 v[100:103], v24 offset:18432
    ds_read_b64_tr_b16 v[36:37], v22 offset:42880
    ds_read_b64_tr_b16 v[38:39], v22 offset:43136
    ds_read_b128 v[104:107], v24 offset:17408
    ds_read_b128 v[108:111], v24 offset:19456
    ds_read_b64_tr_b16 v[40:41], v22 offset:51072
    ds_read_b64_tr_b16 v[42:43], v22 offset:51328
    ds_read_b128 v[112:115], v24 offset:20480
    ds_read_b128 v[116:119], v24 offset:22528
    ds_read_b64_tr_b16 v[44:45], v22 offset:51584
    ds_read_b64_tr_b16 v[46:47], v22 offset:51840
    ds_read_b128 v[120:123], v24 offset:21504
    ds_read_b128 v[124:127], v24 offset:23552
    s_waitcnt lgkmcnt(12)
    v_mfma_f32_32x32x16_bf16 v[64:79], v[32:35], v[96:99], v[64:79]
    v_mfma_f32_32x32x16_bf16 v[80:95], v[32:35], v[100:103], v[80:95]
    s_add_u32 m0, s49, 0
    s_add_u32 s59, s79, 0
    buffer_load_dwordx4 v5, s[24:27], s59 offen lds
    ds_read_b64_tr_b16 v[32:33], v23 offset:6528
    ds_read_b64_tr_b16 v[34:35], v23 offset:6784
    ds_read_b128 v[96:99], v24 offset:24576
    ds_read_b128 v[100:103], v24 offset:26624
    s_waitcnt lgkmcnt(12)
    v_mfma_f32_32x32x16_bf16 v[64:79], v[36:39], v[104:107], v[64:79]
    v_mfma_f32_32x32x16_bf16 v[80:95], v[36:39], v[108:111], v[80:95]
    s_add_u32 m0, s49, 1088
    s_add_u32 s60, s79, 1024
    buffer_load_dwordx4 v5, s[24:27], s60 offen lds
    ds_read_b64_tr_b16 v[36:37], v23 offset:7040
    ds_read_b64_tr_b16 v[38:39], v23 offset:7296
    ds_read_b128 v[104:107], v24 offset:25600
    ds_read_b128 v[108:111], v24 offset:27648
    s_waitcnt lgkmcnt(12)
    v_mfma_f32_32x32x16_bf16 v[64:79], v[40:43], v[112:115], v[64:79]
    v_mfma_f32_32x32x16_bf16 v[80:95], v[40:43], v[116:119], v[80:95]
    s_add_u32 m0, s49, 2176
    s_add_u32 s61, s79, 2048
    buffer_load_dwordx4 v5, s[24:27], s61 offen lds
    ds_read_b64_tr_b16 v[40:41], v23 offset:15232
    ds_read_b64_tr_b16 v[42:43], v23 offset:15488
    ds_read_b128 v[112:115], v24 offset:28672
    ds_read_b128 v[116:119], v24 offset:30720
    s_waitcnt lgkmcnt(12)
    v_mfma_f32_32x32x16_bf16 v[64:79], v[44:47], v[120:123], v[64:79]
    v_mfma_f32_32x32x16_bf16 v[80:95], v[44:47], v[124:127], v[80:95]
    s_add_u32 m0, s49, 3264
    s_add_u32 s62, s79, 3072
    buffer_load_dwordx4 v5, s[24:27], s62 offen lds
    ds_read_b64_tr_b16 v[44:45], v23 offset:15744
    ds_read_b64_tr_b16 v[46:47], v23 offset:16000
    ds_read_b128 v[120:123], v24 offset:29696
    ds_read_b128 v[124:127], v24 offset:31744
    s_waitcnt lgkmcnt(12)
    v_mfma_f32_32x32x16_bf16 v[64:79], v[32:35], v[96:99], v[64:79]
    v_mfma_f32_32x32x16_bf16 v[80:95], v[32:35], v[100:103], v[80:95]
    s_add_u32 m0, s49, 4352
    s_add_u32 s63, s79, 4096
    buffer_load_dwordx4 v5, s[24:27], s63 offen lds
    s_waitcnt lgkmcnt(8)
    v_mfma_f32_32x32x16_bf16 v[64:79], v[36:39], v[104:107], v[64:79]
    v_mfma_f32_32x32x16_bf16 v[80:95], v[36:39], v[108:111], v[80:95]
    s_add_u32 m0, s49, 5440
    s_add_u32 s56, s79, 5120
    buffer_load_dwordx4 v5, s[24:27], s56 offen lds
    s_waitcnt lgkmcnt(4)
    v_mfma_f32_32x32x16_bf16 v[64:79], v[40:43], v[112:115], v[64:79]
    v_mfma_f32_32x32x16_bf16 v[80:95], v[40:43], v[116:119], v[80:95]
    s_add_u32 m0, s49, 6528
    s_add_u32 s57, s79, 6144
    buffer_load_dwordx4 v5, s[24:27], s57 offen lds
    s_waitcnt lgkmcnt(0)
    v_mfma_f32_32x32x16_bf16 v[64:79], v[44:47], v[120:123], v[64:79]
    v_mfma_f32_32x32x16_bf16 v[80:95], v[44:47], v[124:127], v[80:95]
    s_add_u32 m0, s49, 7616
    s_add_u32 s58, s79, 7168
    buffer_load_dwordx4 v5, s[24:27], s58 offen lds
    s_waitcnt vmcnt(9)
    s_barrier
    ds_read_b64_tr_b16 v[32:33], v21 offset:0
    ds_read_b64_tr_b16 v[34:35], v21 offset:256
    ds_read_b128 v[96:99], v24 offset:0
    ds_read_b128 v[100:103], v24 offset:2048
    ds_read_b64_tr_b16 v[36:37], v21 offset:512
    ds_read_b64_tr_b16 v[38:39], v21 offset:768
    ds_read_b128 v[104:107], v24 offset:1024
    ds_read_b128 v[108:111], v24 offset:3072
    ds_read_b64_tr_b16 v[40:41], v21 offset:8704
    ds_read_b64_tr_b16 v[42:43], v21 offset:8960
    ds_read_b128 v[112:115], v24 offset:4096
    ds_read_b128 v[116:119], v24 offset:6144
    ds_read_b64_tr_b16 v[44:45], v21 offset:9216
    ds_read_b64_tr_b16 v[46:47], v21 offset:9472
    ds_read_b128 v[120:123], v24 offset:5120
    ds_read_b128 v[124:127], v24 offset:7168
    s_waitcnt lgkmcnt(12)
    v_mfma_f32_32x32x16_bf16 v[64:79], v[32:35], v[96:99], v[64:79]
    v_mfma_f32_32x32x16_bf16 v[80:95], v[32:35], v[100:103], v[80:95]
    s_add_u32 m0, s65, 0
    s_add_u32 s59, s64, 0
    buffer_load_dwordx4 v6, s[32:35], s59 offen lds
    ds_read_b64_tr_b16 v[32:33], v21 offset:17408
    ds_read_b64_tr_b16 v[34:35], v21 offset:17664
    ds_read_b128 v[96:99], v24 offset:8192
    ds_read_b128 v[100:103], v24 offset:10240
    s_waitcnt lgkmcnt(12)
    v_mfma_f32_32x32x16_bf16 v[64:79], v[36:39], v[104:107], v[64:79]
    v_mfma_f32_32x32x16_bf16 v[80:95], v[36:39], v[108:111], v[80:95]
    s_add_u32 m0, s65, 1088
    s_add_u32 s60, s64, 1024
    buffer_load_dwordx4 v6, s[32:35], s60 offen lds
    ds_read_b64_tr_b16 v[36:37], v21 offset:17920
    ds_read_b64_tr_b16 v[38:39], v21 offset:18176
    ds_read_b128 v[104:107], v24 offset:9216
    ds_read_b128 v[108:111], v24 offset:11264
    s_waitcnt lgkmcnt(12)
    v_mfma_f32_32x32x16_bf16 v[64:79], v[40:43], v[112:115], v[64:79]
    v_mfma_f32_32x32x16_bf16 v[80:95], v[40:43], v[116:119], v[80:95]
    s_add_u32 m0, s65, 2176
    s_add_u32 s61, s64, 2048
    buffer_load_dwordx4 v6, s[32:35], s61 offen lds
    ds_read_b64_tr_b16 v[40:41], v21 offset:26112
    ds_read_b64_tr_b16 v[42:43], v21 offset:26368
    ds_read_b128 v[112:115], v24 offset:12288
    ds_read_b128 v[116:119], v24 offset:14336
    s_waitcnt lgkmcnt(12)
    v_mfma_f32_32x32x16_bf16 v[64:79], v[44:47], v[120:123], v[64:79]
    v_mfma_f32_32x32x16_bf16 v[80:95], v[44:47], v[124:127], v[80:95]
    s_add_u32 m0, s65, 3264
    s_add_u32 s62, s64, 3072
    buffer_load_dwordx4 v6, s[32:35], s62 offen lds
    ds_read_b64_tr_b16 v[44:45], v21 offset:26624
    ds_read_b64_tr_b16 v[46:47], v21 offset:26880
    ds_read_b128 v[120:123], v24 offset:13312
    ds_read_b128 v[124:127], v24 offset:15360
    s_waitcnt lgkmcnt(12)
    v_mfma_f32_32x32x16_bf16 v[64:79], v[32:35], v[96:99], v[64:79]
    v_mfma_f32_32x32x16_bf16 v[80:95], v[32:35], v[100:103], v[80:95]
    s_waitcnt lgkmcnt(8)
    v_mfma_f32_32x32x16_bf16 v[64:79], v[36:39], v[104:107], v[64:79]
    v_mfma_f32_32x32x16_bf16 v[80:95], v[36:39], v[108:111], v[80:95]
    s_waitcnt lgkmcnt(4)
    v_mfma_f32_32x32x16_bf16 v[64:79], v[40:43], v[112:115], v[64:79]
    v_mfma_f32_32x32x16_bf16 v[80:95], v[40:43], v[116:119], v[80:95]
    s_waitcnt lgkmcnt(0)
    v_mfma_f32_32x32x16_bf16 v[64:79], v[44:47], v[120:123], v[64:79]
    v_mfma_f32_32x32x16_bf16 v[80:95], v[44:47], v[124:127], v[80:95]
    s_waitcnt vmcnt(0)
    s_barrier
    ds_read_b32 v48, v25 offset:0
    ds_read_b32 v49, v25 offset:256
    ds_read_b32 v50, v25 offset:512
    ds_read_b32 v51, v25 offset:768
    ds_read_b32 v52, v25 offset:128
    ds_read_b32 v53, v25 offset:384
    ds_read_b32 v54, v25 offset:640
    ds_read_b32 v55, v25 offset:896
    ds_read_b64_tr_b16 v[32:33], v22 offset:7552
    ds_read_b64_tr_b16 v[34:35], v22 offset:7808
    ds_read_b128 v[96:99], v24 offset:16384
    ds_read_b128 v[100:103], v24 offset:18432
    ds_read_b64_tr_b16 v[36:37], v22 offset:8064
    ds_read_b64_tr_b16 v[38:39], v22 offset:8320
    ds_read_b128 v[104:107], v24 offset:17408
    ds_read_b128 v[108:111], v24 offset:19456
    ds_read_b64_tr_b16 v[40:41], v22 offset:16256
    ds_read_b64_tr_b16 v[42:43], v22 offset:16512
    ds_read_b128 v[112:115], v24 offset:20480
    ds_read_b128 v[116:119], v24 offset:22528
    ds_read_b64_tr_b16 v[44:45], v22 offset:16768
    ds_read_b64_tr_b16 v[46:47], v22 offset:17024
    ds_read_b128 v[120:123], v24 offset:21504
    ds_read_b128 v[124:127], v24 offset:23552
    s_waitcnt lgkmcnt(12)
    v_mfma_f32_32x32x16_bf16 v[64:79], v[32:35], v[96:99], v[64:79]
    v_mfma_f32_32x32x16_bf16 v[80:95], v[32:35], v[100:103], v[80:95]
    ds_read_b64_tr_b16 v[32:33], v22 offset:24960
    ds_read_b64_tr_b16 v[34:35], v22 offset:25216
    ds_read_b128 v[96:99], v24 offset:24576
    ds_read_b128 v[100:103], v24 offset:26624
    s_waitcnt lgkmcnt(12)
    v_mfma_f32_32x32x16_bf16 v[64:79], v[36:39], v[104:107], v[64:79]
    v_mfma_f32_32x32x16_bf16 v[80:95], v[36:39], v[108:111], v[80:95]
    ds_read_b64_tr_b16 v[36:37], v22 offset:25472
    ds_read_b64_tr_b16 v[38:39], v22 offset:25728
    ds_read_b128 v[104:107], v24 offset:25600
    ds_read_b128 v[108:111], v24 offset:27648
    s_waitcnt lgkmcnt(12)
    v_mfma_f32_32x32x16_bf16 v[64:79], v[40:43], v[112:115], v[64:79]
    v_mfma_f32_32x32x16_bf16 v[80:95], v[40:43], v[116:119], v[80:95]
    ds_read_b64_tr_b16 v[40:41], v22 offset:33664
    ds_read_b64_tr_b16 v[42:43], v22 offset:33920
    ds_read_b128 v[112:115], v24 offset:28672
    ds_read_b128 v[116:119], v24 offset:30720
    s_waitcnt lgkmcnt(12)
    v_mfma_f32_32x32x16_bf16 v[64:79], v[44:47], v[120:123], v[64:79]
    v_mfma_f32_32x32x16_bf16 v[80:95], v[44:47], v[124:127], v[80:95]
    ds_read_b64_tr_b16 v[44:45], v22 offset:34176
    ds_read_b64_tr_b16 v[46:47], v22 offset:34432
    ds_read_b128 v[120:123], v24 offset:29696
    ds_read_b128 v[124:127], v24 offset:31744
    s_waitcnt lgkmcnt(12)
    v_mfma_f32_32x32x16_bf16 v[64:79], v[32:35], v[96:99], v[64:79]
    v_mfma_f32_32x32x16_bf16 v[80:95], v[32:35], v[100:103], v[80:95]
    s_waitcnt lgkmcnt(8)
    v_mfma_f32_32x32x16_bf16 v[64:79], v[36:39], v[104:107], v[64:79]
    v_mfma_f32_32x32x16_bf16 v[80:95], v[36:39], v[108:111], v[80:95]
    s_waitcnt lgkmcnt(4)
    v_mfma_f32_32x32x16_bf16 v[64:79], v[40:43], v[112:115], v[64:79]
    v_mfma_f32_32x32x16_bf16 v[80:95], v[40:43], v[116:119], v[80:95]
    s_waitcnt lgkmcnt(0)
    v_mfma_f32_32x32x16_bf16 v[64:79], v[44:47], v[120:123], v[64:79]
    v_mfma_f32_32x32x16_bf16 v[80:95], v[44:47], v[124:127], v[80:95]
    v_add_f32 v48, v48, v49
    v_add_f32 v50, v50, v51
    v_add_f32 v52, v52, v53
    v_add_f32 v54, v54, v55
    v_add_f32 v48, v48, v50
    v_add_f32 v52, v52, v54
    v_rcp_f32 v48, v48
    v_rcp_f32 v52, v52
    s_nop 2
    v_mul_f32 v64, v64, v48
    v_mul_f32 v65, v65, v48
    v_mul_f32 v66, v66, v48
    v_mul_f32 v67, v67, v48
    v_mul_f32 v68, v68, v48
    v_mul_f32 v69, v69, v48
    v_mul_f32 v70, v70, v48
    v_mul_f32 v71, v71, v48
    v_cvt_pk_bf16_f32 v128, v64, v65
    v_cvt_pk_bf16_f32 v129, v66, v67
    v_cvt_pk_bf16_f32 v130, v68, v69
    v_cvt_pk_bf16_f32 v131, v70, v71
    s_add_u32 s63, s67, 0
    buffer_store_dwordx4 v[128:131], v5, s[36:39], s63 offen sc1
    v_mul_f32 v72, v72, v48
    v_mul_f32 v73, v73, v48
    v_mul_f32 v74, v74, v48
    v_mul_f32 v75, v75, v48
    v_mul_f32 v76, v76, v48
    v_mul_f32 v77, v77, v48
    v_mul_f32 v78, v78, v48
    v_mul_f32 v79, v79, v48
    v_cvt_pk_bf16_f32 v132, v72, v73
    v_cvt_pk_bf16_f32 v133, v74, v75
    v_cvt_pk_bf16_f32 v134, v76, v77
    v_cvt_pk_bf16_f32 v135, v78, v79
    s_add_u32 s56, s67, 1024
    buffer_store_dwordx4 v[132:135], v5, s[36:39], s56 offen sc1
    v_mul_f32 v80, v80, v52
    v_mul_f32 v81, v81, v52
    v_mul_f32 v82, v82, v52
    v_mul_f32 v83, v83, v52
    v_mul_f32 v84, v84, v52
    v_mul_f32 v85, v85, v52
    v_mul_f32 v86, v86, v52
    v_mul_f32 v87, v87, v52
    v_cvt_pk_bf16_f32 v136, v80, v81
    v_cvt_pk_bf16_f32 v137, v82, v83
    v_cvt_pk_bf16_f32 v138, v84, v85
    v_cvt_pk_bf16_f32 v139, v86, v87
    s_add_u32 s57, s67, 262144
    buffer_store_dwordx4 v[136:139], v5, s[36:39], s57 offen sc1
    v_mul_f32 v88, v88, v52
    v_mul_f32 v89, v89, v52
    v_mul_f32 v90, v90, v52
    v_mul_f32 v91, v91, v52
    v_mul_f32 v92, v92, v52
    v_mul_f32 v93, v93, v52
    v_mul_f32 v94, v94, v52
    v_mul_f32 v95, v95, v52
    v_cvt_pk_bf16_f32 v140, v88, v89
    v_cvt_pk_bf16_f32 v141, v90, v91
    v_cvt_pk_bf16_f32 v142, v92, v93
    v_cvt_pk_bf16_f32 v143, v94, v95
    s_add_u32 s58, s67, 263168
    buffer_store_dwordx4 v[140:143], v5, s[36:39], s58 offen sc1
    s_endpgm
.globl gqa_oproj_kernel
.p2align 8
.type gqa_oproj_kernel,@function
gqa_oproj_kernel:
    s_cmp_ge_u32 s2, 256
    s_cbranch_scc1 K2_END
    s_load_dwordx2 s[4:5], s[0:1], 40
    s_load_dwordx2 s[6:7], s[0:1], 56
    v_and_b32 v1, 63, v0
    v_lshrrev_b32 v3, 6, v0
    s_nop 0
    v_readfirstlane_b32 s24, v3
    v_lshlrev_b32 v2, 4, v1
    s_and_b32 s32, s2, 7
    s_lshr_b32 s33, s2, 3
    s_lshr_b32 s25, s32, 1
    s_lshl_b32 s25, s25, 2
    s_and_b32 s34, s33, 3
    s_add_u32 s25, s25, s34
    s_and_b32 s26, s32, 1
    s_lshl_b32 s26, s26, 3
    s_lshr_b32 s34, s33, 2
    s_add_u32 s26, s26, s34
    s_lshl_b32 s32, s24, 15
    s_lshl_b32 s27, s26, 18
    s_add_u32 s27, s27, s32
    s_add_u32 s27, s27, 4194304
    s_lshl_b32 s28, s25, 18
    s_add_u32 s28, s28, s32
    s_waitcnt lgkmcnt(0)
    s_mov_b32 s20, s4
    s_and_b32 s21, s5, 0xffff
    s_mov_b32 s22, 524288
    s_mov_b32 s23, 0x00020000
    s_mov_b32 s16, s6
    s_and_b32 s17, s7, 0xffff
    s_mov_b32 s18, 8388608
    s_mov_b32 s19, 0x00020000
    buffer_load_dwordx4 v[32:35], v2, s[16:19], s27 offen
    buffer_load_dwordx4 v[36:39], v2, s[16:19], s28 offen
    buffer_load_dwordx4 v[40:43], v2, s[16:19], s27 offen offset:1024
    buffer_load_dwordx4 v[44:47], v2, s[16:19], s28 offen offset:1024
    buffer_load_dwordx4 v[48:51], v2, s[16:19], s27 offen offset:2048
    buffer_load_dwordx4 v[52:55], v2, s[16:19], s28 offen offset:2048
    buffer_load_dwordx4 v[56:59], v2, s[16:19], s27 offen offset:3072
    buffer_load_dwordx4 v[60:63], v2, s[16:19], s28 offen offset:3072
    s_add_u32 s27, s27, 4096
    s_add_u32 s28, s28, 4096
    buffer_load_dwordx4 v[64:67], v2, s[16:19], s27 offen
    buffer_load_dwordx4 v[68:71], v2, s[16:19], s28 offen
    buffer_load_dwordx4 v[72:75], v2, s[16:19], s27 offen offset:1024
    buffer_load_dwordx4 v[76:79], v2, s[16:19], s28 offen offset:1024
    buffer_load_dwordx4 v[80:83], v2, s[16:19], s27 offen offset:2048
    buffer_load_dwordx4 v[84:87], v2, s[16:19], s28 offen offset:2048
    buffer_load_dwordx4 v[88:91], v2, s[16:19], s27 offen offset:3072
    buffer_load_dwordx4 v[92:95], v2, s[16:19], s28 offen offset:3072
    s_add_u32 s27, s27, 4096
    s_add_u32 s28, s28, 4096
    buffer_load_dwordx4 v[96:99], v2, s[16:19], s27 offen
    buffer_load_dwordx4 v[100:103], v2, s[16:19], s28 offen
    buffer_load_dwordx4 v[104:107], v2, s[16:19], s27 offen offset:1024
    buffer_load_dwordx4 v[108:111], v2, s[16:19], s28 offen offset:1024
    buffer_load_dwordx4 v[112:115], v2, s[16:19], s27 offen offset:2048
    buffer_load_dwordx4 v[116:119], v2, s[16:19], s28 offen offset:2048
    buffer_load_dwordx4 v[120:123], v2, s[16:19], s27 offen offset:3072
    buffer_load_dwordx4 v[124:127], v2, s[16:19], s28 offen offset:3072
    s_add_u32 s27, s27, 4096
    s_add_u32 s28, s28, 4096
    buffer_load_dwordx4 v[128:131], v2, s[16:19], s27 offen
    buffer_load_dwordx4 v[132:135], v2, s[16:19], s28 offen
    buffer_load_dwordx4 v[136:139], v2, s[16:19], s27 offen offset:1024
    buffer_load_dwordx4 v[140:143], v2, s[16:19], s28 offen offset:1024
    buffer_load_dwordx4 v[144:147], v2, s[16:19], s27 offen offset:2048
    buffer_load_dwordx4 v[148:151], v2, s[16:19], s28 offen offset:2048
    buffer_load_dwordx4 v[152:155], v2, s[16:19], s27 offen offset:3072
    buffer_load_dwordx4 v[156:159], v2, s[16:19], s28 offen offset:3072
    s_waitcnt vmcnt(30)
    v_mfma_f32_32x32x16_bf16 v[4:19], v[32:35], v[36:39], 0
    s_add_u32 s27, s27, 4096
    s_add_u32 s28, s28, 4096
    buffer_load_dwordx4 v[32:35], v2, s[16:19], s27 offen
    buffer_load_dwordx4 v[36:39], v2, s[16:19], s28 offen
    s_waitcnt vmcnt(30)
    v_mfma_f32_32x32x16_bf16 v[4:19], v[40:43], v[44:47], v[4:19]
    buffer_load_dwordx4 v[40:43], v2, s[16:19], s27 offen offset:1024
    buffer_load_dwordx4 v[44:47], v2, s[16:19], s28 offen offset:1024
    s_waitcnt vmcnt(30)
    v_mfma_f32_32x32x16_bf16 v[4:19], v[48:51], v[52:55], v[4:19]
    buffer_load_dwordx4 v[48:51], v2, s[16:19], s27 offen offset:2048
    buffer_load_dwordx4 v[52:55], v2, s[16:19], s28 offen offset:2048
    s_waitcnt vmcnt(30)
    v_mfma_f32_32x32x16_bf16 v[4:19], v[56:59], v[60:63], v[4:19]
    buffer_load_dwordx4 v[56:59], v2, s[16:19], s27 offen offset:3072
    buffer_load_dwordx4 v[60:63], v2, s[16:19], s28 offen offset:3072
    s_waitcnt vmcnt(30)
    v_mfma_f32_32x32x16_bf16 v[4:19], v[64:67], v[68:71], v[4:19]
    s_add_u32 s27, s27, 4096
    s_add_u32 s28, s28, 4096
    buffer_load_dwordx4 v[64:67], v2, s[16:19], s27 offen
    buffer_load_dwordx4 v[68:71], v2, s[16:19], s28 offen
    s_waitcnt vmcnt(30)
    v_mfma_f32_32x32x16_bf16 v[4:19], v[72:75], v[76:79], v[4:19]
    buffer_load_dwordx4 v[72:75], v2, s[16:19], s27 offen offset:1024
    buffer_load_dwordx4 v[76:79], v2, s[16:19], s28 offen offset:1024
    s_waitcnt vmcnt(30)
    v_mfma_f32_32x32x16_bf16 v[4:19], v[80:83], v[84:87], v[4:19]
    buffer_load_dwordx4 v[80:83], v2, s[16:19], s27 offen offset:2048
    buffer_load_dwordx4 v[84:87], v2, s[16:19], s28 offen offset:2048
    s_waitcnt vmcnt(30)
    v_mfma_f32_32x32x16_bf16 v[4:19], v[88:91], v[92:95], v[4:19]
    buffer_load_dwordx4 v[88:91], v2, s[16:19], s27 offen offset:3072
    buffer_load_dwordx4 v[92:95], v2, s[16:19], s28 offen offset:3072
    s_waitcnt vmcnt(30)
    v_mfma_f32_32x32x16_bf16 v[4:19], v[96:99], v[100:103], v[4:19]
    s_add_u32 s27, s27, 4096
    s_add_u32 s28, s28, 4096
    buffer_load_dwordx4 v[96:99], v2, s[16:19], s27 offen
    buffer_load_dwordx4 v[100:103], v2, s[16:19], s28 offen
    s_waitcnt vmcnt(30)
    v_mfma_f32_32x32x16_bf16 v[4:19], v[104:107], v[108:111], v[4:19]
    buffer_load_dwordx4 v[104:107], v2, s[16:19], s27 offen offset:1024
    buffer_load_dwordx4 v[108:111], v2, s[16:19], s28 offen offset:1024
    s_waitcnt vmcnt(30)
    v_mfma_f32_32x32x16_bf16 v[4:19], v[112:115], v[116:119], v[4:19]
    buffer_load_dwordx4 v[112:115], v2, s[16:19], s27 offen offset:2048
    buffer_load_dwordx4 v[116:119], v2, s[16:19], s28 offen offset:2048
    s_waitcnt vmcnt(30)
    v_mfma_f32_32x32x16_bf16 v[4:19], v[120:123], v[124:127], v[4:19]
    buffer_load_dwordx4 v[120:123], v2, s[16:19], s27 offen offset:3072
    buffer_load_dwordx4 v[124:127], v2, s[16:19], s28 offen offset:3072
    s_waitcnt vmcnt(30)
    v_mfma_f32_32x32x16_bf16 v[4:19], v[128:131], v[132:135], v[4:19]
    s_add_u32 s27, s27, 4096
    s_add_u32 s28, s28, 4096
    buffer_load_dwordx4 v[128:131], v2, s[16:19], s27 offen
    buffer_load_dwordx4 v[132:135], v2, s[16:19], s28 offen
    s_waitcnt vmcnt(30)
    v_mfma_f32_32x32x16_bf16 v[4:19], v[136:139], v[140:143], v[4:19]
    buffer_load_dwordx4 v[136:139], v2, s[16:19], s27 offen offset:1024
    buffer_load_dwordx4 v[140:143], v2, s[16:19], s28 offen offset:1024
    s_waitcnt vmcnt(30)
    v_mfma_f32_32x32x16_bf16 v[4:19], v[144:147], v[148:151], v[4:19]
    buffer_load_dwordx4 v[144:147], v2, s[16:19], s27 offen offset:2048
    buffer_load_dwordx4 v[148:151], v2, s[16:19], s28 offen offset:2048
    s_waitcnt vmcnt(30)
    v_mfma_f32_32x32x16_bf16 v[4:19], v[152:155], v[156:159], v[4:19]
    buffer_load_dwordx4 v[152:155], v2, s[16:19], s27 offen offset:3072
    buffer_load_dwordx4 v[156:159], v2, s[16:19], s28 offen offset:3072
    s_waitcnt vmcnt(30)
    v_mfma_f32_32x32x16_bf16 v[4:19], v[32:35], v[36:39], v[4:19]
    s_waitcnt vmcnt(28)
    v_mfma_f32_32x32x16_bf16 v[4:19], v[40:43], v[44:47], v[4:19]
    s_waitcnt vmcnt(26)
    v_mfma_f32_32x32x16_bf16 v[4:19], v[48:51], v[52:55], v[4:19]
    s_waitcnt vmcnt(24)
    v_mfma_f32_32x32x16_bf16 v[4:19], v[56:59], v[60:63], v[4:19]
    s_waitcnt vmcnt(22)
    v_mfma_f32_32x32x16_bf16 v[4:19], v[64:67], v[68:71], v[4:19]
    s_waitcnt vmcnt(20)
    v_mfma_f32_32x32x16_bf16 v[4:19], v[72:75], v[76:79], v[4:19]
    s_waitcnt vmcnt(18)
    v_mfma_f32_32x32x16_bf16 v[4:19], v[80:83], v[84:87], v[4:19]
    s_waitcnt vmcnt(16)
    v_mfma_f32_32x32x16_bf16 v[4:19], v[88:91], v[92:95], v[4:19]
    s_waitcnt vmcnt(14)
    v_mfma_f32_32x32x16_bf16 v[4:19], v[96:99], v[100:103], v[4:19]
    s_waitcnt vmcnt(12)
    v_mfma_f32_32x32x16_bf16 v[4:19], v[104:107], v[108:111], v[4:19]
    s_waitcnt vmcnt(10)
    v_mfma_f32_32x32x16_bf16 v[4:19], v[112:115], v[116:119], v[4:19]
    s_waitcnt vmcnt(8)
    v_mfma_f32_32x32x16_bf16 v[4:19], v[120:123], v[124:127], v[4:19]
    s_waitcnt vmcnt(6)
    v_mfma_f32_32x32x16_bf16 v[4:19], v[128:131], v[132:135], v[4:19]
    s_waitcnt vmcnt(4)
    v_mfma_f32_32x32x16_bf16 v[4:19], v[136:139], v[140:143], v[4:19]
    s_waitcnt vmcnt(2)
    v_mfma_f32_32x32x16_bf16 v[4:19], v[144:147], v[148:151], v[4:19]
    s_waitcnt vmcnt(0)
    v_mfma_f32_32x32x16_bf16 v[4:19], v[152:155], v[156:159], v[4:19]
    s_lshl_b32 s32, s24, 12
    v_add_u32 v3, s32, v2
    s_nop 9
    ds_write_b128 v3, v[4:7] offset:0
    ds_write_b128 v3, v[8:11] offset:1024
    ds_write_b128 v3, v[12:15] offset:2048
    ds_write_b128 v3, v[16:19] offset:3072
    s_waitcnt lgkmcnt(0)
    s_barrier
    s_cmp_ge_u32 s24, 4
    s_cbranch_scc1 K2_END
    s_lshl_b32 s32, s24, 10
    v_add_u32 v3, s32, v2
    ds_read_b128 v[32:35], v3 offset:0
    ds_read_b128 v[36:39], v3 offset:4096
    ds_read_b128 v[40:43], v3 offset:8192
    ds_read_b128 v[44:47], v3 offset:12288
    ds_read_b128 v[48:51], v3 offset:16384
    ds_read_b128 v[52:55], v3 offset:20480
    ds_read_b128 v[56:59], v3 offset:24576
    ds_read_b128 v[60:63], v3 offset:28672
    s_waitcnt lgkmcnt(6)
    v_add_f32 v4, v32, v36
    v_add_f32 v5, v33, v37
    v_add_f32 v6, v34, v38
    v_add_f32 v7, v35, v39
    s_waitcnt lgkmcnt(5)
    v_add_f32 v4, v4, v40
    v_add_f32 v5, v5, v41
    v_add_f32 v6, v6, v42
    v_add_f32 v7, v7, v43
    s_waitcnt lgkmcnt(4)
    v_add_f32 v4, v4, v44
    v_add_f32 v5, v5, v45
    v_add_f32 v6, v6, v46
    v_add_f32 v7, v7, v47
    s_waitcnt lgkmcnt(3)
    v_add_f32 v4, v4, v48
    v_add_f32 v5, v5, v49
    v_add_f32 v6, v6, v50
    v_add_f32 v7, v7, v51
    s_waitcnt lgkmcnt(2)
    v_add_f32 v4, v4, v52
    v_add_f32 v5, v5, v53
    v_add_f32 v6, v6, v54
    v_add_f32 v7, v7, v55
    s_waitcnt lgkmcnt(1)
    v_add_f32 v4, v4, v56
    v_add_f32 v5, v5, v57
    v_add_f32 v6, v6, v58
    v_add_f32 v7, v7, v59
    s_waitcnt lgkmcnt(0)
    v_add_f32 v4, v4, v60
    v_add_f32 v5, v5, v61
    v_add_f32 v6, v6, v62
    v_add_f32 v7, v7, v63
    v_cvt_pk_bf16_f32 v8, v4, v5
    v_cvt_pk_bf16_f32 v9, v6, v7
    v_and_b32 v20, 31, v1
    v_lshlrev_b32 v20, 10, v20
    v_lshrrev_b32 v21, 5, v1
    v_lshl_add_u32 v20, v21, 3, v20
    s_lshl_b32 s32, s25, 15
    s_lshl_b32 s33, s26, 6
    s_add_u32 s32, s32, s33
    s_lshl_b32 s33, s24, 4
    s_add_u32 s32, s32, s33
    buffer_store_dwordx2 v[8:9], v20, s[20:23], s32 offen
K2_END:
    s_endpgm
.section .rodata,"a"
.p2align 6
.amdhsa_kernel gqa_attn_kernel
  .amdhsa_next_free_vgpr 256
  .amdhsa_next_free_sgpr 100
  .amdhsa_accum_offset 256
  .amdhsa_group_segment_fixed_size 0
  .amdhsa_kernarg_size 64
  .amdhsa_user_sgpr_count 2
  .amdhsa_user_sgpr_kernarg_segment_ptr 1
  .amdhsa_system_sgpr_workgroup_id_x 1
.end_amdhsa_kernel
.p2align 6
.amdhsa_kernel gqa_oproj_kernel
  .amdhsa_next_free_vgpr 160
  .amdhsa_next_free_sgpr 96
  .amdhsa_accum_offset 160
  .amdhsa_group_segment_fixed_size 0
  .amdhsa_kernarg_size 64
  .amdhsa_user_sgpr_count 2
  .amdhsa_user_sgpr_kernarg_segment_ptr 1
  .amdhsa_system_sgpr_workgroup_id_x 1
.end_amdhsa_kernel
```
